```python
import torch

def _softmax(x, axis=-1):
    return torch.softmax(x, dim=axis)

def _gelu(x):
    return torch.nn.functional.gelu(x, approximate='tanh')

def _silu(x):
    return torch.nn.functional.silu(x)

def _sigmoid(x):
    return torch.sigmoid(x)

def _layernorm(x, axis=-1, eps=1e-05):
    m = x.mean(dim=axis, keepdim=True)
    v = x.var(dim=axis, keepdim=True, unbiased=False)
    return (x - m) / torch.sqrt(v + eps)

def _scatter_add(tgt, idx, src, axis=0):
    return tgt.clone().index_add_(axis, idx, src)

def _segment_sum(src, seg, n):
    out = torch.zeros((n,) + src.shape[1:], dtype=src.dtype)
    return out.index_add_(0, seg, src)

def _pad(x, pw):
    flat = tuple((v for pair in reversed(pw) for v in pair))
    return torch.nn.functional.pad(x, flat)
kernel_name = 'recurrent_scan__memory_aug_recurrent_mem_tr__glu_gated_geglu__prompt'

def setup_inputs():

    _w = lambda a: (lambda t: t.to(torch.bfloat16) if t.is_floating_point() else t)(torch.as_tensor(a))

    def _A_setup():
        B, S, Dm = (1, 2048, 512)
        H, Dh = (32, 128)
        M, seg = (8, 32)
        seg = min(seg, S)
        S = S // seg * seg
        return {'x': _w((lambda *s: torch.randn(*s, dtype=torch.bfloat16) * 0.1)(B, S, Dm)), 'mem0': _w((lambda *s: torch.randn(*s, dtype=torch.bfloat16) * 1.6)(B, M, Dm)), 'Wq': _w((lambda *s: torch.randn(*s, dtype=torch.bfloat16) * 0.8)(Dm, H, Dh) * Dm ** (-0.5)), 'Wk': _w((lambda *s: torch.randn(*s, dtype=torch.bfloat16) * 0.8)(Dm, H, Dh) * Dm ** (-0.5)), 'Wv': _w((lambda *s: torch.randn(*s, dtype=torch.bfloat16) * 1.6)(Dm, H, Dh) * Dm ** (-0.5)), 'Wo': _w((lambda *s: torch.randn(*s, dtype=torch.bfloat16) * 1.6)(H, Dh, Dm) * (H * Dh) ** (-0.5)), 'seg_len': seg}
    _A_in = _A_setup()

    def _B_setup():
        B, S, Dm, Df = (1, 2048, 512, 1792)
        return {'x': _w((lambda *s: torch.randn(*s, dtype=torch.bfloat16) * 0.1)(B, S, Dm)), 'w_gate': _w((lambda *s: torch.randn(*s, dtype=torch.bfloat16) * 0.4)(Dm, Df) * Dm ** (-0.5)), 'w_up': _w((lambda *s: torch.randn(*s, dtype=torch.bfloat16) * 0.4)(Dm, Df) * Dm ** (-0.5)), 'w_down': _w((lambda *s: torch.randn(*s, dtype=torch.bfloat16) * 0.4)(Df, Dm) * Df ** (-0.5))}
    _B_in = _B_setup()
    return {'A_x': _A_in['x'], 'A_mem0': _A_in['mem0'], 'A_Wq': _A_in['Wq'], 'A_Wk': _A_in['Wk'], 'A_Wv': _A_in['Wv'], 'A_Wo': _A_in['Wo'], 'A_seg_len': _A_in['seg_len'], 'B_x': _B_in['x'], 'B_w_gate': _B_in['w_gate'], 'B_w_up': _B_in['w_up'], 'B_w_down': _B_in['w_down']}

def reference(A_x, A_mem0, A_Wq, A_Wk, A_Wv, A_Wo, A_seg_len, B_x, B_w_gate, B_w_up, B_w_down):

    def _A_ref(x, mem0, Wq, Wk, Wv, Wo, seg_len):
        B, S, Dm = x.shape
        H, Dh = (Wq.shape[1], Wq.shape[2])
        M = mem0.shape[1]
        scale = Dh ** (-0.5)
        n_seg = S // seg_len
        L = M + seg_len
        idx = torch.arange(L)
        mask = (idx[:, None] < M) | (idx[:, None] >= idx[None, :])
        mem = mem0
        outs = []
        for s in range(n_seg):
            xs = x[:, s * seg_len:(s + 1) * seg_len, :].clone()
            h = torch.concatenate([mem, xs], axis=1)
            q = torch.einsum('btd,dhe->bhte', h, Wq)
            k = torch.einsum('btd,dhe->bhte', h, Wk)
            v = torch.einsum('btd,dhe->bhte', h, Wv)
            scores = torch.einsum('bhqe,bhke->bhqk', q, k) * scale
            scores = torch.where(mask[None, None], scores, -1000000000.0)
            p = _softmax(scores, axis=-1)
            o = torch.einsum('bhqk,bhke->bhqe', p, v)
            o = torch.einsum('bhte,hed->btd', o, Wo)
            mem = o[:, :M, :].clone()
            outs.append(o[:, M:, :])
        return torch.concatenate(outs, axis=1)

    def _B_ref(x, w_gate, w_up, w_down):
        g = torch.einsum('bsd,df->bsf', x, w_gate)
        u = torch.einsum('bsd,df->bsf', x, w_up)
        h = _gelu(g) * u
        return torch.einsum('bsf,fd->bsd', h, w_down)
    x = A_x
    xn = _layernorm(x, axis=-1)
    s = _A_ref(xn, A_mem0, A_Wq, A_Wk, A_Wv, A_Wo, A_seg_len)
    g = _silu(_B_ref(xn, B_w_gate, B_w_up, B_w_down))
    return x + s * g
```

```asm
; @launch grid=(256,1,1) block=(256,1,1) lds=163840
.amdgcn_target "amdgcn-amd-amdhsa--gfx950"
.text
.globl recurrent_scan__memory_aug_recurrent_mem_tr__glu_gated_geglu__prompt_kernel
.p2align 8
.type recurrent_scan__memory_aug_recurrent_mem_tr__glu_gated_geglu__prompt_kernel,@function
recurrent_scan__memory_aug_recurrent_mem_tr__glu_gated_geglu__prompt_kernel:
  s_cmp_ge_u32 s2, 256
  s_cbranch_scc1 EXIT
  s_load_dwordx2 s[44:45], s[0:1], 96
  s_load_dwordx2 s[4:5], s[0:1], 0
  s_load_dwordx2 s[8:9], s[0:1], 8
  s_load_dwordx2 s[12:13], s[0:1], 16
  s_load_dwordx2 s[16:17], s[0:1], 24
  s_load_dwordx2 s[20:21], s[0:1], 32
  s_load_dwordx2 s[24:25], s[0:1], 40
  s_load_dwordx2 s[28:29], s[0:1], 64
  s_load_dwordx2 s[32:33], s[0:1], 72
  s_load_dwordx2 s[36:37], s[0:1], 80
  s_load_dwordx2 s[40:41], s[0:1], 88
  s_load_dwordx2 s[48:49], s[0:1], 104
  s_mov_b32 s6, 2097152
  s_mov_b32 s7, 0x20000
  s_mov_b32 s10, 8192
  s_mov_b32 s11, 0x20000
  s_mov_b32 s14, 4194304
  s_mov_b32 s15, 0x20000
  s_mov_b32 s18, 4194304
  s_mov_b32 s19, 0x20000
  s_mov_b32 s22, 4194304
  s_mov_b32 s23, 0x20000
  s_mov_b32 s26, 4194304
  s_mov_b32 s27, 0x20000
  s_mov_b32 s30, 1835008
  s_mov_b32 s31, 0x20000
  s_mov_b32 s34, 1835008
  s_mov_b32 s35, 0x20000
  s_mov_b32 s38, 1835008
  s_mov_b32 s39, 0x20000
  s_mov_b32 s42, 2097152
  s_mov_b32 s43, 0x20000
  s_mov_b32 s46, 256
  s_mov_b32 s47, 0x20000
  s_mov_b32 s50, 268435456
  s_mov_b32 s51, 0x20000
  s_getreg_b32 s55, hwreg(HW_REG_XCC_ID)
  s_and_b32 s55, s55, 7
  v_lshrrev_b32 v3, 6, v0
  v_and_b32 v1, 63, v0
  v_readfirstlane_b32 s52, v3
  v_lshlrev_b32 v2, 4, v1
  s_mov_b32 s60, 131072
  v_mov_b32 v5, 0
  s_waitcnt lgkmcnt(0)
  s_xor_b32 s54, s2, 1
  s_and_b32 s54, s54, 7
  s_lshr_b32 s53, s2, 3
  s_cmp_eq_u32 s54, 0
  s_cbranch_scc1 CHAIN
WORKER:
  s_mov_b32 s83, s54
  s_mov_b32 s84, s53
  s_sub_u32 s64, s54, 1
  s_lshl_b32 s56, s64, 5
  s_add_u32 s85, s56, s53
  s_mul_i32 s53, s85, 293
  s_lshr_b32 s53, s53, 11
  s_mul_i32 s56, s53, 7
  s_sub_u32 s64, s85, s56
  s_add_u32 s54, s64, 1
  s_cmp_eq_u32 s64, 0
  s_cselect_b32 s65, 10, 9
  s_lshl_b32 s68, s52, 15
  v_and_b32 v4, 7, v1
  v_lshrrev_b32 v5, 3, v1
  v_lshlrev_b32 v6, 10, v4
  v_lshl_add_u32 v6, v5, 4, v6
  s_lshl_b32 s58, s64, 15
  s_lshl_b32 s59, s52, 13
  s_add_u32 s58, s58, s59
  buffer_load_dwordx4 v[16:19], v6, s[4:7], s58 offen offset:0
  buffer_load_dwordx4 v[20:23], v6, s[4:7], s58 offen offset:128
  buffer_load_dwordx4 v[24:27], v6, s[4:7], s58 offen offset:256
  buffer_load_dwordx4 v[28:31], v6, s[4:7], s58 offen offset:384
  buffer_load_dwordx4 v[32:35], v6, s[4:7], s58 offen offset:512
  buffer_load_dwordx4 v[36:39], v6, s[4:7], s58 offen offset:640
  buffer_load_dwordx4 v[40:43], v6, s[4:7], s58 offen offset:768
  buffer_load_dwordx4 v[44:47], v6, s[4:7], s58 offen offset:896
  s_lshl_b32 s56, s52, 5
  s_add_u32 s56, s56, s53
  s_add_u32 s56, s56, 4
  s_lshl_b32 s57, s65, 2
  s_cmp_lt_u32 s56, s57
  s_cselect_b32 s69, 1, 0
  s_lshr_b32 s57, s56, 2
  s_mul_i32 s57, s57, 7
  s_add_u32 s57, s57, s64
  s_and_b32 s56, s56, 3
  s_lshl_b32 s58, s57, 15
  s_lshl_b32 s59, s56, 13
  s_add_u32 s67, s58, s59
  s_lshl_b32 s59, s56, 7
  s_add_u32 s66, s58, s59
  v_lshlrev_b32 v7, 4, v4
  v_lshl_add_u32 v7, v5, 9, v7
  s_cmp_eq_u32 s69, 0
  s_cbranch_scc1 W_NOLN0
  buffer_load_dwordx4 v[128:131], v6, s[4:7], s67 offen offset:0
  buffer_load_dwordx4 v[132:135], v6, s[4:7], s67 offen offset:128
  buffer_load_dwordx4 v[136:139], v6, s[4:7], s67 offen offset:256
  buffer_load_dwordx4 v[140:143], v6, s[4:7], s67 offen offset:384
  buffer_load_dwordx4 v[144:147], v6, s[4:7], s67 offen offset:512
  buffer_load_dwordx4 v[148:151], v6, s[4:7], s67 offen offset:640
  buffer_load_dwordx4 v[152:155], v6, s[4:7], s67 offen offset:768
  buffer_load_dwordx4 v[156:159], v6, s[4:7], s67 offen offset:896
W_NOLN0:
  v_lshrrev_b32 v4, 2, v1
  v_and_b32 v5, 3, v1
  v_lshlrev_b32 v8, 13, v4
  v_lshl_add_u32 v8, v5, 4, v8
  s_lshl_b32 s56, s53, 8
  s_lshl_b32 s57, s52, 6
  s_add_u32 s56, s56, s57
  v_add_u32 v8, s56, v8
  v_lshrrev_b32 v4, 5, v1
  v_bfe_u32 v5, v1, 2, 2
  v_lshlrev_b32 v4, 9, v4
  v_lshl_add_u32 v4, v5, 6, v4
  v_add_u32 v4, s68, v4
  v_bfe_u32 v5, v1, 4, 1
  v_and_b32 v11, 1, v1
  v_bfe_u32 v12, v1, 1, 1
  v_lshl_add_u32 v9, v5, 5, v4
  v_lshl_add_u32 v9, v11, 4, v9
  v_lshl_add_u32 v9, v12, 3, v9
  v_and_b32 v11, 3, v1
  v_lshl_add_u32 v10, v11, 4, v4
  v_lshl_add_u32 v10, v5, 3, v10
  v_lshrrev_b32 v4, 4, v1
  v_and_b32 v5, 15, v1
  v_lshlrev_b32 v112, 13, v4
  v_lshlrev_b32 v4, 2, v4
  v_xor_b32 v4, v4, v5
  v_lshl_add_u32 v112, v4, 4, v112
  s_lshl_b32 s56, s53, 8
  s_add_u32 s56, s56, s68
  v_add_u32 v112, s56, v112
  s_lshl_b32 s74, s52, 10
  s_add_u32 m0, s74, 0
  s_mov_b32 s56, 0
  buffer_load_dwordx4 v112, s[16:19], s56 offen lds
  s_add_u32 m0, s74, 4096
  s_mov_b32 s56, 0
  buffer_load_dwordx4 v112, s[20:23], s56 offen lds
  s_add_u32 m0, s74, 8192
  s_mov_b32 s56, 131072
  buffer_load_dwordx4 v112, s[16:19], s56 offen lds
  s_add_u32 m0, s74, 12288
  s_mov_b32 s56, 131072
  buffer_load_dwordx4 v112, s[20:23], s56 offen lds
  s_add_u32 m0, s74, 16384
  s_mov_b32 s56, 262144
  buffer_load_dwordx4 v112, s[16:19], s56 offen lds
  s_add_u32 m0, s74, 20480
  s_mov_b32 s56, 262144
  buffer_load_dwordx4 v112, s[20:23], s56 offen lds
  s_add_u32 m0, s74, 24576
  s_mov_b32 s56, 393216
  buffer_load_dwordx4 v112, s[16:19], s56 offen lds
  s_add_u32 m0, s74, 28672
  s_mov_b32 s56, 393216
  buffer_load_dwordx4 v112, s[20:23], s56 offen lds
  s_add_u32 m0, s74, 32768
  s_mov_b32 s56, 524288
  buffer_load_dwordx4 v112, s[16:19], s56 offen lds
  s_add_u32 m0, s74, 36864
  s_mov_b32 s56, 524288
  buffer_load_dwordx4 v112, s[20:23], s56 offen lds
  s_add_u32 m0, s74, 40960
  s_mov_b32 s56, 655360
  buffer_load_dwordx4 v112, s[16:19], s56 offen lds
  s_add_u32 m0, s74, 45056
  s_mov_b32 s56, 655360
  buffer_load_dwordx4 v112, s[20:23], s56 offen lds
  s_add_u32 m0, s74, 49152
  s_mov_b32 s56, 786432
  buffer_load_dwordx4 v112, s[16:19], s56 offen lds
  s_add_u32 m0, s74, 53248
  s_mov_b32 s56, 786432
  buffer_load_dwordx4 v112, s[20:23], s56 offen lds
  s_add_u32 m0, s74, 57344
  s_mov_b32 s56, 917504
  buffer_load_dwordx4 v112, s[16:19], s56 offen lds
  s_add_u32 m0, s74, 61440
  s_mov_b32 s56, 917504
  buffer_load_dwordx4 v112, s[20:23], s56 offen lds
  s_add_u32 m0, s74, 65536
  s_mov_b32 s56, 1048576
  buffer_load_dwordx4 v112, s[16:19], s56 offen lds
  s_add_u32 m0, s74, 69632
  s_mov_b32 s56, 1048576
  buffer_load_dwordx4 v112, s[20:23], s56 offen lds
  s_add_u32 m0, s74, 73728
  s_mov_b32 s56, 1179648
  buffer_load_dwordx4 v112, s[16:19], s56 offen lds
  s_add_u32 m0, s74, 77824
  s_mov_b32 s56, 1179648
  buffer_load_dwordx4 v112, s[20:23], s56 offen lds
  s_add_u32 m0, s74, 81920
  s_mov_b32 s56, 1310720
  buffer_load_dwordx4 v112, s[16:19], s56 offen lds
  s_add_u32 m0, s74, 86016
  s_mov_b32 s56, 1310720
  buffer_load_dwordx4 v112, s[20:23], s56 offen lds
  s_add_u32 m0, s74, 90112
  s_mov_b32 s56, 1441792
  buffer_load_dwordx4 v112, s[16:19], s56 offen lds
  s_add_u32 m0, s74, 94208
  s_mov_b32 s56, 1441792
  buffer_load_dwordx4 v112, s[20:23], s56 offen lds
  s_add_u32 m0, s74, 98304
  s_mov_b32 s56, 1572864
  buffer_load_dwordx4 v112, s[16:19], s56 offen lds
  s_add_u32 m0, s74, 102400
  s_mov_b32 s56, 1572864
  buffer_load_dwordx4 v112, s[20:23], s56 offen lds
  s_add_u32 m0, s74, 106496
  s_mov_b32 s56, 1703936
  buffer_load_dwordx4 v112, s[16:19], s56 offen lds
  s_add_u32 m0, s74, 110592
  s_mov_b32 s56, 1703936
  buffer_load_dwordx4 v112, s[20:23], s56 offen lds
  s_add_u32 m0, s74, 114688
  s_mov_b32 s56, 1835008
  buffer_load_dwordx4 v112, s[16:19], s56 offen lds
  s_add_u32 m0, s74, 118784
  s_mov_b32 s56, 1835008
  buffer_load_dwordx4 v112, s[20:23], s56 offen lds
  s_add_u32 m0, s74, 122880
  s_mov_b32 s56, 1966080
  buffer_load_dwordx4 v112, s[16:19], s56 offen lds
  s_add_u32 m0, s74, 126976
  s_mov_b32 s56, 1966080
  buffer_load_dwordx4 v112, s[20:23], s56 offen lds
  v_lshrrev_b32 v4, 5, v1
  v_bfe_u32 v5, v1, 2, 2
  v_lshlrev_b32 v4, 11, v4
  v_lshl_add_u32 v4, v5, 8, v4
  v_xor_b32 v5, s52, v5
  v_lshl_add_u32 v4, v5, 6, v4
  v_and_b32 v5, 63, v9
  v_add_u32 v113, v4, v5
  v_add_u32 v114, 0x10000, v113
  v_and_b32 v5, 63, v10
  v_add_u32 v115, v4, v5
  v_add_u32 v116, 0x10000, v115
  s_lshl_b32 s56, s52, 7
  s_add_u32 s56, s56, 131072
  v_add_u32 v6, s56, v7
  s_lshl_b32 s56, s53, 7
  s_lshl_b32 s57, s54, 2
  s_add_u32 s71, s56, s57
  s_add_u32 s71, s71, 89128960
  s_lshl_b32 s56, s54, 12
  s_lshl_b32 s57, s53, 7
  s_add_u32 s72, s56, s57
  s_add_u32 s72, s72, 89137152
  s_waitcnt vmcnt(32)
  s_mov_b32 s73, s69
  s_cmp_eq_u32 s69, 0
  s_cbranch_scc1 W_LNL
  v_lshlrev_b32 v48, 16, v128
  v_and_b32 v49, 0xffff0000, v128
  v_lshlrev_b32 v50, 16, v129
  v_and_b32 v51, 0xffff0000, v129
  v_lshlrev_b32 v52, 16, v130
  v_and_b32 v53, 0xffff0000, v130
  v_lshlrev_b32 v54, 16, v131
  v_and_b32 v55, 0xffff0000, v131
  v_lshlrev_b32 v56, 16, v132
  v_and_b32 v57, 0xffff0000, v132
  v_lshlrev_b32 v58, 16, v133
  v_and_b32 v59, 0xffff0000, v133
  v_lshlrev_b32 v60, 16, v134
  v_and_b32 v61, 0xffff0000, v134
  v_lshlrev_b32 v62, 16, v135
  v_and_b32 v63, 0xffff0000, v135
  v_lshlrev_b32 v64, 16, v136
  v_and_b32 v65, 0xffff0000, v136
  v_lshlrev_b32 v66, 16, v137
  v_and_b32 v67, 0xffff0000, v137
  v_lshlrev_b32 v68, 16, v138
  v_and_b32 v69, 0xffff0000, v138
  v_lshlrev_b32 v70, 16, v139
  v_and_b32 v71, 0xffff0000, v139
  v_lshlrev_b32 v72, 16, v140
  v_and_b32 v73, 0xffff0000, v140
  v_lshlrev_b32 v74, 16, v141
  v_and_b32 v75, 0xffff0000, v141
  v_lshlrev_b32 v76, 16, v142
  v_and_b32 v77, 0xffff0000, v142
  v_lshlrev_b32 v78, 16, v143
  v_and_b32 v79, 0xffff0000, v143
  v_lshlrev_b32 v80, 16, v144
  v_and_b32 v81, 0xffff0000, v144
  v_lshlrev_b32 v82, 16, v145
  v_and_b32 v83, 0xffff0000, v145
  v_lshlrev_b32 v84, 16, v146
  v_and_b32 v85, 0xffff0000, v146
  v_lshlrev_b32 v86, 16, v147
  v_and_b32 v87, 0xffff0000, v147
  v_lshlrev_b32 v88, 16, v148
  v_and_b32 v89, 0xffff0000, v148
  v_lshlrev_b32 v90, 16, v149
  v_and_b32 v91, 0xffff0000, v149
  v_lshlrev_b32 v92, 16, v150
  v_and_b32 v93, 0xffff0000, v150
  v_lshlrev_b32 v94, 16, v151
  v_and_b32 v95, 0xffff0000, v151
  v_lshlrev_b32 v96, 16, v152
  v_and_b32 v97, 0xffff0000, v152
  v_lshlrev_b32 v98, 16, v153
  v_and_b32 v99, 0xffff0000, v153
  v_lshlrev_b32 v100, 16, v154
  v_and_b32 v101, 0xffff0000, v154
  v_lshlrev_b32 v102, 16, v155
  v_and_b32 v103, 0xffff0000, v155
  v_lshlrev_b32 v104, 16, v156
  v_and_b32 v105, 0xffff0000, v156
  v_lshlrev_b32 v106, 16, v157
  v_and_b32 v107, 0xffff0000, v157
  v_lshlrev_b32 v108, 16, v158
  v_and_b32 v109, 0xffff0000, v158
  v_lshlrev_b32 v110, 16, v159
  v_and_b32 v111, 0xffff0000, v159
  v_mov_b64 v[128:129], v[16:17]
  v_mov_b64 v[130:131], v[18:19]
  v_mov_b64 v[132:133], v[20:21]
  v_mov_b64 v[134:135], v[22:23]
  v_mov_b64 v[136:137], v[24:25]
  v_mov_b64 v[138:139], v[26:27]
  v_mov_b64 v[140:141], v[28:29]
  v_mov_b64 v[142:143], v[30:31]
  v_mov_b64 v[144:145], v[32:33]
  v_mov_b64 v[146:147], v[34:35]
  v_mov_b64 v[148:149], v[36:37]
  v_mov_b64 v[150:151], v[38:39]
  v_mov_b64 v[152:153], v[40:41]
  v_mov_b64 v[154:155], v[42:43]
  v_mov_b64 v[156:157], v[44:45]
  v_mov_b64 v[158:159], v[46:47]
  s_branch W_LN
W_LNL:
  v_lshlrev_b32 v48, 16, v16
  v_and_b32 v49, 0xffff0000, v16
  v_lshlrev_b32 v50, 16, v17
  v_and_b32 v51, 0xffff0000, v17
  v_lshlrev_b32 v52, 16, v18
  v_and_b32 v53, 0xffff0000, v18
  v_lshlrev_b32 v54, 16, v19
  v_and_b32 v55, 0xffff0000, v19
  v_lshlrev_b32 v56, 16, v20
  v_and_b32 v57, 0xffff0000, v20
  v_lshlrev_b32 v58, 16, v21
  v_and_b32 v59, 0xffff0000, v21
  v_lshlrev_b32 v60, 16, v22
  v_and_b32 v61, 0xffff0000, v22
  v_lshlrev_b32 v62, 16, v23
  v_and_b32 v63, 0xffff0000, v23
  v_lshlrev_b32 v64, 16, v24
  v_and_b32 v65, 0xffff0000, v24
  v_lshlrev_b32 v66, 16, v25
  v_and_b32 v67, 0xffff0000, v25
  v_lshlrev_b32 v68, 16, v26
  v_and_b32 v69, 0xffff0000, v26
  v_lshlrev_b32 v70, 16, v27
  v_and_b32 v71, 0xffff0000, v27
  v_lshlrev_b32 v72, 16, v28
  v_and_b32 v73, 0xffff0000, v28
  v_lshlrev_b32 v74, 16, v29
  v_and_b32 v75, 0xffff0000, v29
  v_lshlrev_b32 v76, 16, v30
  v_and_b32 v77, 0xffff0000, v30
  v_lshlrev_b32 v78, 16, v31
  v_and_b32 v79, 0xffff0000, v31
  v_lshlrev_b32 v80, 16, v32
  v_and_b32 v81, 0xffff0000, v32
  v_lshlrev_b32 v82, 16, v33
  v_and_b32 v83, 0xffff0000, v33
  v_lshlrev_b32 v84, 16, v34
  v_and_b32 v85, 0xffff0000, v34
  v_lshlrev_b32 v86, 16, v35
  v_and_b32 v87, 0xffff0000, v35
  v_lshlrev_b32 v88, 16, v36
  v_and_b32 v89, 0xffff0000, v36
  v_lshlrev_b32 v90, 16, v37
  v_and_b32 v91, 0xffff0000, v37
  v_lshlrev_b32 v92, 16, v38
  v_and_b32 v93, 0xffff0000, v38
  v_lshlrev_b32 v94, 16, v39
  v_and_b32 v95, 0xffff0000, v39
  v_lshlrev_b32 v96, 16, v40
  v_and_b32 v97, 0xffff0000, v40
  v_lshlrev_b32 v98, 16, v41
  v_and_b32 v99, 0xffff0000, v41
  v_lshlrev_b32 v100, 16, v42
  v_and_b32 v101, 0xffff0000, v42
  v_lshlrev_b32 v102, 16, v43
  v_and_b32 v103, 0xffff0000, v43
  v_lshlrev_b32 v104, 16, v44
  v_and_b32 v105, 0xffff0000, v44
  v_lshlrev_b32 v106, 16, v45
  v_and_b32 v107, 0xffff0000, v45
  v_lshlrev_b32 v108, 16, v46
  v_and_b32 v109, 0xffff0000, v46
  v_lshlrev_b32 v110, 16, v47
  v_and_b32 v111, 0xffff0000, v47
W_LN:
  v_add_f32 v12, v48, v49
  v_add_f32 v13, v50, v51
  v_add_f32 v12, v12, v52
  v_add_f32 v13, v13, v53
  v_add_f32 v12, v12, v54
  v_add_f32 v13, v13, v55
  v_add_f32 v12, v12, v56
  v_add_f32 v13, v13, v57
  v_add_f32 v12, v12, v58
  v_add_f32 v13, v13, v59
  v_add_f32 v12, v12, v60
  v_add_f32 v13, v13, v61
  v_add_f32 v12, v12, v62
  v_add_f32 v13, v13, v63
  v_add_f32 v12, v12, v64
  v_add_f32 v13, v13, v65
  v_add_f32 v12, v12, v66
  v_add_f32 v13, v13, v67
  v_add_f32 v12, v12, v68
  v_add_f32 v13, v13, v69
  v_add_f32 v12, v12, v70
  v_add_f32 v13, v13, v71
  v_add_f32 v12, v12, v72
  v_add_f32 v13, v13, v73
  v_add_f32 v12, v12, v74
  v_add_f32 v13, v13, v75
  v_add_f32 v12, v12, v76
  v_add_f32 v13, v13, v77
  v_add_f32 v12, v12, v78
  v_add_f32 v13, v13, v79
  v_add_f32 v12, v12, v80
  v_add_f32 v13, v13, v81
  v_add_f32 v12, v12, v82
  v_add_f32 v13, v13, v83
  v_add_f32 v12, v12, v84
  v_add_f32 v13, v13, v85
  v_add_f32 v12, v12, v86
  v_add_f32 v13, v13, v87
  v_add_f32 v12, v12, v88
  v_add_f32 v13, v13, v89
  v_add_f32 v12, v12, v90
  v_add_f32 v13, v13, v91
  v_add_f32 v12, v12, v92
  v_add_f32 v13, v13, v93
  v_add_f32 v12, v12, v94
  v_add_f32 v13, v13, v95
  v_add_f32 v12, v12, v96
  v_add_f32 v13, v13, v97
  v_add_f32 v12, v12, v98
  v_add_f32 v13, v13, v99
  v_add_f32 v12, v12, v100
  v_add_f32 v13, v13, v101
  v_add_f32 v12, v12, v102
  v_add_f32 v13, v13, v103
  v_add_f32 v12, v12, v104
  v_add_f32 v13, v13, v105
  v_add_f32 v12, v12, v106
  v_add_f32 v13, v13, v107
  v_add_f32 v12, v12, v108
  v_add_f32 v13, v13, v109
  v_add_f32 v12, v12, v110
  v_add_f32 v13, v13, v111
  v_add_f32 v12, v12, v13
  s_nop 1
  v_add_f32_dpp v12, v12, v12 row_ror:8 row_mask:0xf bank_mask:0xf
  v_mov_b32 v13, v12
  s_nop 1
  v_permlane16_swap_b32 v12, v13
  v_add_f32 v12, v12, v13
  v_mov_b32 v13, v12
  s_nop 1
  v_permlane32_swap_b32 v12, v13
  v_add_f32 v12, v12, v13
  v_mul_f32 v12, 0x3b000000, v12
  v_mov_b32 v14, 0
  v_mov_b32 v15, 0
  v_sub_f32 v4, v48, v12
  v_sub_f32 v5, v49, v12
  v_fmac_f32 v14, v4, v4
  v_fmac_f32 v15, v5, v5
  v_sub_f32 v4, v50, v12
  v_sub_f32 v5, v51, v12
  v_fmac_f32 v14, v4, v4
  v_fmac_f32 v15, v5, v5
  v_sub_f32 v4, v52, v12
  v_sub_f32 v5, v53, v12
  v_fmac_f32 v14, v4, v4
  v_fmac_f32 v15, v5, v5
  v_sub_f32 v4, v54, v12
  v_sub_f32 v5, v55, v12
  v_fmac_f32 v14, v4, v4
  v_fmac_f32 v15, v5, v5
  v_sub_f32 v4, v56, v12
  v_sub_f32 v5, v57, v12
  v_fmac_f32 v14, v4, v4
  v_fmac_f32 v15, v5, v5
  v_sub_f32 v4, v58, v12
  v_sub_f32 v5, v59, v12
  v_fmac_f32 v14, v4, v4
  v_fmac_f32 v15, v5, v5
  v_sub_f32 v4, v60, v12
  v_sub_f32 v5, v61, v12
  v_fmac_f32 v14, v4, v4
  v_fmac_f32 v15, v5, v5
  v_sub_f32 v4, v62, v12
  v_sub_f32 v5, v63, v12
  v_fmac_f32 v14, v4, v4
  v_fmac_f32 v15, v5, v5
  v_sub_f32 v4, v64, v12
  v_sub_f32 v5, v65, v12
  v_fmac_f32 v14, v4, v4
  v_fmac_f32 v15, v5, v5
  v_sub_f32 v4, v66, v12
  v_sub_f32 v5, v67, v12
  v_fmac_f32 v14, v4, v4
  v_fmac_f32 v15, v5, v5
  v_sub_f32 v4, v68, v12
  v_sub_f32 v5, v69, v12
  v_fmac_f32 v14, v4, v4
  v_fmac_f32 v15, v5, v5
  v_sub_f32 v4, v70, v12
  v_sub_f32 v5, v71, v12
  v_fmac_f32 v14, v4, v4
  v_fmac_f32 v15, v5, v5
  v_sub_f32 v4, v72, v12
  v_sub_f32 v5, v73, v12
  v_fmac_f32 v14, v4, v4
  v_fmac_f32 v15, v5, v5
  v_sub_f32 v4, v74, v12
  v_sub_f32 v5, v75, v12
  v_fmac_f32 v14, v4, v4
  v_fmac_f32 v15, v5, v5
  v_sub_f32 v4, v76, v12
  v_sub_f32 v5, v77, v12
  v_fmac_f32 v14, v4, v4
  v_fmac_f32 v15, v5, v5
  v_sub_f32 v4, v78, v12
  v_sub_f32 v5, v79, v12
  v_fmac_f32 v14, v4, v4
  v_fmac_f32 v15, v5, v5
  v_sub_f32 v4, v80, v12
  v_sub_f32 v5, v81, v12
  v_fmac_f32 v14, v4, v4
  v_fmac_f32 v15, v5, v5
  v_sub_f32 v4, v82, v12
  v_sub_f32 v5, v83, v12
  v_fmac_f32 v14, v4, v4
  v_fmac_f32 v15, v5, v5
  v_sub_f32 v4, v84, v12
  v_sub_f32 v5, v85, v12
  v_fmac_f32 v14, v4, v4
  v_fmac_f32 v15, v5, v5
  v_sub_f32 v4, v86, v12
  v_sub_f32 v5, v87, v12
  v_fmac_f32 v14, v4, v4
  v_fmac_f32 v15, v5, v5
  v_sub_f32 v4, v88, v12
  v_sub_f32 v5, v89, v12
  v_fmac_f32 v14, v4, v4
  v_fmac_f32 v15, v5, v5
  v_sub_f32 v4, v90, v12
  v_sub_f32 v5, v91, v12
  v_fmac_f32 v14, v4, v4
  v_fmac_f32 v15, v5, v5
  v_sub_f32 v4, v92, v12
  v_sub_f32 v5, v93, v12
  v_fmac_f32 v14, v4, v4
  v_fmac_f32 v15, v5, v5
  v_sub_f32 v4, v94, v12
  v_sub_f32 v5, v95, v12
  v_fmac_f32 v14, v4, v4
  v_fmac_f32 v15, v5, v5
  v_sub_f32 v4, v96, v12
  v_sub_f32 v5, v97, v12
  v_fmac_f32 v14, v4, v4
  v_fmac_f32 v15, v5, v5
  v_sub_f32 v4, v98, v12
  v_sub_f32 v5, v99, v12
  v_fmac_f32 v14, v4, v4
  v_fmac_f32 v15, v5, v5
  v_sub_f32 v4, v100, v12
  v_sub_f32 v5, v101, v12
  v_fmac_f32 v14, v4, v4
  v_fmac_f32 v15, v5, v5
  v_sub_f32 v4, v102, v12
  v_sub_f32 v5, v103, v12
  v_fmac_f32 v14, v4, v4
  v_fmac_f32 v15, v5, v5
  v_sub_f32 v4, v104, v12
  v_sub_f32 v5, v105, v12
  v_fmac_f32 v14, v4, v4
  v_fmac_f32 v15, v5, v5
  v_sub_f32 v4, v106, v12
  v_sub_f32 v5, v107, v12
  v_fmac_f32 v14, v4, v4
  v_fmac_f32 v15, v5, v5
  v_sub_f32 v4, v108, v12
  v_sub_f32 v5, v109, v12
  v_fmac_f32 v14, v4, v4
  v_fmac_f32 v15, v5, v5
  v_sub_f32 v4, v110, v12
  v_sub_f32 v5, v111, v12
  v_fmac_f32 v14, v4, v4
  v_fmac_f32 v15, v5, v5
  v_add_f32 v14, v14, v15
  s_nop 1
  v_add_f32_dpp v14, v14, v14 row_ror:8 row_mask:0xf bank_mask:0xf
  v_mov_b32 v13, v14
  s_nop 1
  v_permlane16_swap_b32 v14, v13
  v_add_f32 v14, v14, v13
  v_mov_b32 v13, v14
  s_nop 1
  v_permlane32_swap_b32 v14, v13
  v_add_f32 v14, v14, v13
  v_mul_f32 v14, 0x3b000000, v14
  v_cvt_pk_bf16_f32 v12, v12, v12
  v_and_b32 v12, 0xffff0000, v12
  v_cvt_pk_bf16_f32 v14, v14, v14
  v_and_b32 v14, 0xffff0000, v14
  v_add_f32 v14, 0x3727c5ac, v14
  v_cvt_pk_bf16_f32 v14, v14, v14
  v_and_b32 v14, 0xffff0000, v14
  v_sqrt_f32 v14, v14
  s_nop 0
  v_cvt_pk_bf16_f32 v14, v14, v14
  v_and_b32 v14, 0xffff0000, v14
  v_rcp_f32 v14, v14
  v_sub_f32 v4, v48, v12
  v_sub_f32 v5, v49, v12
  v_cvt_pk_bf16_f32 v4, v4, v5
  v_and_b32 v5, 0xffff0000, v4
  v_lshlrev_b32 v4, 16, v4
  v_mul_f32 v5, v5, v14
  v_mul_f32 v4, v4, v14
  v_cvt_pk_bf16_f32 v16, v4, v5
  v_sub_f32 v4, v50, v12
  v_sub_f32 v5, v51, v12
  v_cvt_pk_bf16_f32 v4, v4, v5
  v_and_b32 v5, 0xffff0000, v4
  v_lshlrev_b32 v4, 16, v4
  v_mul_f32 v5, v5, v14
  v_mul_f32 v4, v4, v14
  v_cvt_pk_bf16_f32 v17, v4, v5
  v_sub_f32 v4, v52, v12
  v_sub_f32 v5, v53, v12
  v_cvt_pk_bf16_f32 v4, v4, v5
  v_and_b32 v5, 0xffff0000, v4
  v_lshlrev_b32 v4, 16, v4
  v_mul_f32 v5, v5, v14
  v_mul_f32 v4, v4, v14
  v_cvt_pk_bf16_f32 v18, v4, v5
  v_sub_f32 v4, v54, v12
  v_sub_f32 v5, v55, v12
  v_cvt_pk_bf16_f32 v4, v4, v5
  v_and_b32 v5, 0xffff0000, v4
  v_lshlrev_b32 v4, 16, v4
  v_mul_f32 v5, v5, v14
  v_mul_f32 v4, v4, v14
  v_cvt_pk_bf16_f32 v19, v4, v5
  v_sub_f32 v4, v56, v12
  v_sub_f32 v5, v57, v12
  v_cvt_pk_bf16_f32 v4, v4, v5
  v_and_b32 v5, 0xffff0000, v4
  v_lshlrev_b32 v4, 16, v4
  v_mul_f32 v5, v5, v14
  v_mul_f32 v4, v4, v14
  v_cvt_pk_bf16_f32 v20, v4, v5
  v_sub_f32 v4, v58, v12
  v_sub_f32 v5, v59, v12
  v_cvt_pk_bf16_f32 v4, v4, v5
  v_and_b32 v5, 0xffff0000, v4
  v_lshlrev_b32 v4, 16, v4
  v_mul_f32 v5, v5, v14
  v_mul_f32 v4, v4, v14
  v_cvt_pk_bf16_f32 v21, v4, v5
  v_sub_f32 v4, v60, v12
  v_sub_f32 v5, v61, v12
  v_cvt_pk_bf16_f32 v4, v4, v5
  v_and_b32 v5, 0xffff0000, v4
  v_lshlrev_b32 v4, 16, v4
  v_mul_f32 v5, v5, v14
  v_mul_f32 v4, v4, v14
  v_cvt_pk_bf16_f32 v22, v4, v5
  v_sub_f32 v4, v62, v12
  v_sub_f32 v5, v63, v12
  v_cvt_pk_bf16_f32 v4, v4, v5
  v_and_b32 v5, 0xffff0000, v4
  v_lshlrev_b32 v4, 16, v4
  v_mul_f32 v5, v5, v14
  v_mul_f32 v4, v4, v14
  v_cvt_pk_bf16_f32 v23, v4, v5
  v_sub_f32 v4, v64, v12
  v_sub_f32 v5, v65, v12
  v_cvt_pk_bf16_f32 v4, v4, v5
  v_and_b32 v5, 0xffff0000, v4
  v_lshlrev_b32 v4, 16, v4
  v_mul_f32 v5, v5, v14
  v_mul_f32 v4, v4, v14
  v_cvt_pk_bf16_f32 v24, v4, v5
  v_sub_f32 v4, v66, v12
  v_sub_f32 v5, v67, v12
  v_cvt_pk_bf16_f32 v4, v4, v5
  v_and_b32 v5, 0xffff0000, v4
  v_lshlrev_b32 v4, 16, v4
  v_mul_f32 v5, v5, v14
  v_mul_f32 v4, v4, v14
  v_cvt_pk_bf16_f32 v25, v4, v5
  v_sub_f32 v4, v68, v12
  v_sub_f32 v5, v69, v12
  v_cvt_pk_bf16_f32 v4, v4, v5
  v_and_b32 v5, 0xffff0000, v4
  v_lshlrev_b32 v4, 16, v4
  v_mul_f32 v5, v5, v14
  v_mul_f32 v4, v4, v14
  v_cvt_pk_bf16_f32 v26, v4, v5
  v_sub_f32 v4, v70, v12
  v_sub_f32 v5, v71, v12
  v_cvt_pk_bf16_f32 v4, v4, v5
  v_and_b32 v5, 0xffff0000, v4
  v_lshlrev_b32 v4, 16, v4
  v_mul_f32 v5, v5, v14
  v_mul_f32 v4, v4, v14
  v_cvt_pk_bf16_f32 v27, v4, v5
  v_sub_f32 v4, v72, v12
  v_sub_f32 v5, v73, v12
  v_cvt_pk_bf16_f32 v4, v4, v5
  v_and_b32 v5, 0xffff0000, v4
  v_lshlrev_b32 v4, 16, v4
  v_mul_f32 v5, v5, v14
  v_mul_f32 v4, v4, v14
  v_cvt_pk_bf16_f32 v28, v4, v5
  v_sub_f32 v4, v74, v12
  v_sub_f32 v5, v75, v12
  v_cvt_pk_bf16_f32 v4, v4, v5
  v_and_b32 v5, 0xffff0000, v4
  v_lshlrev_b32 v4, 16, v4
  v_mul_f32 v5, v5, v14
  v_mul_f32 v4, v4, v14
  v_cvt_pk_bf16_f32 v29, v4, v5
  v_sub_f32 v4, v76, v12
  v_sub_f32 v5, v77, v12
  v_cvt_pk_bf16_f32 v4, v4, v5
  v_and_b32 v5, 0xffff0000, v4
  v_lshlrev_b32 v4, 16, v4
  v_mul_f32 v5, v5, v14
  v_mul_f32 v4, v4, v14
  v_cvt_pk_bf16_f32 v30, v4, v5
  v_sub_f32 v4, v78, v12
  v_sub_f32 v5, v79, v12
  v_cvt_pk_bf16_f32 v4, v4, v5
  v_and_b32 v5, 0xffff0000, v4
  v_lshlrev_b32 v4, 16, v4
  v_mul_f32 v5, v5, v14
  v_mul_f32 v4, v4, v14
  v_cvt_pk_bf16_f32 v31, v4, v5
  v_sub_f32 v4, v80, v12
  v_sub_f32 v5, v81, v12
  v_cvt_pk_bf16_f32 v4, v4, v5
  v_and_b32 v5, 0xffff0000, v4
  v_lshlrev_b32 v4, 16, v4
  v_mul_f32 v5, v5, v14
  v_mul_f32 v4, v4, v14
  v_cvt_pk_bf16_f32 v32, v4, v5
  v_sub_f32 v4, v82, v12
  v_sub_f32 v5, v83, v12
  v_cvt_pk_bf16_f32 v4, v4, v5
  v_and_b32 v5, 0xffff0000, v4
  v_lshlrev_b32 v4, 16, v4
  v_mul_f32 v5, v5, v14
  v_mul_f32 v4, v4, v14
  v_cvt_pk_bf16_f32 v33, v4, v5
  v_sub_f32 v4, v84, v12
  v_sub_f32 v5, v85, v12
  v_cvt_pk_bf16_f32 v4, v4, v5
  v_and_b32 v5, 0xffff0000, v4
  v_lshlrev_b32 v4, 16, v4
  v_mul_f32 v5, v5, v14
  v_mul_f32 v4, v4, v14
  v_cvt_pk_bf16_f32 v34, v4, v5
  v_sub_f32 v4, v86, v12
  v_sub_f32 v5, v87, v12
  v_cvt_pk_bf16_f32 v4, v4, v5
  v_and_b32 v5, 0xffff0000, v4
  v_lshlrev_b32 v4, 16, v4
  v_mul_f32 v5, v5, v14
  v_mul_f32 v4, v4, v14
  v_cvt_pk_bf16_f32 v35, v4, v5
  v_sub_f32 v4, v88, v12
  v_sub_f32 v5, v89, v12
  v_cvt_pk_bf16_f32 v4, v4, v5
  v_and_b32 v5, 0xffff0000, v4
  v_lshlrev_b32 v4, 16, v4
  v_mul_f32 v5, v5, v14
  v_mul_f32 v4, v4, v14
  v_cvt_pk_bf16_f32 v36, v4, v5
  v_sub_f32 v4, v90, v12
  v_sub_f32 v5, v91, v12
  v_cvt_pk_bf16_f32 v4, v4, v5
  v_and_b32 v5, 0xffff0000, v4
  v_lshlrev_b32 v4, 16, v4
  v_mul_f32 v5, v5, v14
  v_mul_f32 v4, v4, v14
  v_cvt_pk_bf16_f32 v37, v4, v5
  v_sub_f32 v4, v92, v12
  v_sub_f32 v5, v93, v12
  v_cvt_pk_bf16_f32 v4, v4, v5
  v_and_b32 v5, 0xffff0000, v4
  v_lshlrev_b32 v4, 16, v4
  v_mul_f32 v5, v5, v14
  v_mul_f32 v4, v4, v14
  v_cvt_pk_bf16_f32 v38, v4, v5
  v_sub_f32 v4, v94, v12
  v_sub_f32 v5, v95, v12
  v_cvt_pk_bf16_f32 v4, v4, v5
  v_and_b32 v5, 0xffff0000, v4
  v_lshlrev_b32 v4, 16, v4
  v_mul_f32 v5, v5, v14
  v_mul_f32 v4, v4, v14
  v_cvt_pk_bf16_f32 v39, v4, v5
  v_sub_f32 v4, v96, v12
  v_sub_f32 v5, v97, v12
  v_cvt_pk_bf16_f32 v4, v4, v5
  v_and_b32 v5, 0xffff0000, v4
  v_lshlrev_b32 v4, 16, v4
  v_mul_f32 v5, v5, v14
  v_mul_f32 v4, v4, v14
  v_cvt_pk_bf16_f32 v40, v4, v5
  v_sub_f32 v4, v98, v12
  v_sub_f32 v5, v99, v12
  v_cvt_pk_bf16_f32 v4, v4, v5
  v_and_b32 v5, 0xffff0000, v4
  v_lshlrev_b32 v4, 16, v4
  v_mul_f32 v5, v5, v14
  v_mul_f32 v4, v4, v14
  v_cvt_pk_bf16_f32 v41, v4, v5
  v_sub_f32 v4, v100, v12
  v_sub_f32 v5, v101, v12
  v_cvt_pk_bf16_f32 v4, v4, v5
  v_and_b32 v5, 0xffff0000, v4
  v_lshlrev_b32 v4, 16, v4
  v_mul_f32 v5, v5, v14
  v_mul_f32 v4, v4, v14
  v_cvt_pk_bf16_f32 v42, v4, v5
  v_sub_f32 v4, v102, v12
  v_sub_f32 v5, v103, v12
  v_cvt_pk_bf16_f32 v4, v4, v5
  v_and_b32 v5, 0xffff0000, v4
  v_lshlrev_b32 v4, 16, v4
  v_mul_f32 v5, v5, v14
  v_mul_f32 v4, v4, v14
  v_cvt_pk_bf16_f32 v43, v4, v5
  v_sub_f32 v4, v104, v12
  v_sub_f32 v5, v105, v12
  v_cvt_pk_bf16_f32 v4, v4, v5
  v_and_b32 v5, 0xffff0000, v4
  v_lshlrev_b32 v4, 16, v4
  v_mul_f32 v5, v5, v14
  v_mul_f32 v4, v4, v14
  v_cvt_pk_bf16_f32 v44, v4, v5
  v_sub_f32 v4, v106, v12
  v_sub_f32 v5, v107, v12
  v_cvt_pk_bf16_f32 v4, v4, v5
  v_and_b32 v5, 0xffff0000, v4
  v_lshlrev_b32 v4, 16, v4
  v_mul_f32 v5, v5, v14
  v_mul_f32 v4, v4, v14
  v_cvt_pk_bf16_f32 v45, v4, v5
  v_sub_f32 v4, v108, v12
  v_sub_f32 v5, v109, v12
  v_cvt_pk_bf16_f32 v4, v4, v5
  v_and_b32 v5, 0xffff0000, v4
  v_lshlrev_b32 v4, 16, v4
  v_mul_f32 v5, v5, v14
  v_mul_f32 v4, v4, v14
  v_cvt_pk_bf16_f32 v46, v4, v5
  v_sub_f32 v4, v110, v12
  v_sub_f32 v5, v111, v12
  v_cvt_pk_bf16_f32 v4, v4, v5
  v_and_b32 v5, 0xffff0000, v4
  v_lshlrev_b32 v4, 16, v4
  v_mul_f32 v5, v5, v14
  v_mul_f32 v4, v4, v14
  v_cvt_pk_bf16_f32 v47, v4, v5
  s_cmp_eq_u32 s73, 1
  s_cbranch_scc0 W_LN1
  s_add_u32 s56, s66, 0
  buffer_store_dwordx4 v[16:19], v7, s[48:51], s56 offen sc1
  s_add_u32 s56, s66, 4096
  buffer_store_dwordx4 v[20:23], v7, s[48:51], s56 offen sc1
  s_add_u32 s56, s66, 8192
  buffer_store_dwordx4 v[24:27], v7, s[48:51], s56 offen sc1
  s_add_u32 s56, s66, 12288
  buffer_store_dwordx4 v[28:31], v7, s[48:51], s56 offen sc1
  s_add_u32 s56, s66, 16384
  buffer_store_dwordx4 v[32:35], v7, s[48:51], s56 offen sc1
  s_add_u32 s56, s66, 20480
  buffer_store_dwordx4 v[36:39], v7, s[48:51], s56 offen sc1
  s_add_u32 s56, s66, 24576
  buffer_store_dwordx4 v[40:43], v7, s[48:51], s56 offen sc1
  s_add_u32 s56, s66, 28672
  buffer_store_dwordx4 v[44:47], v7, s[48:51], s56 offen sc1
  s_branch W_NOZ
W_LN1:
  ds_write_b128 v6, v[16:19] offset:0
  ds_write_b128 v6, v[20:23] offset:4096
  ds_write_b128 v6, v[24:27] offset:8192
  ds_write_b128 v6, v[28:31] offset:12288
  ds_write_b128 v6, v[32:35] offset:16384
  ds_write_b128 v6, v[36:39] offset:20480
  ds_write_b128 v6, v[40:43] offset:24576
  ds_write_b128 v6, v[44:47] offset:28672
  s_cmp_eq_u32 s73, 2
  s_cbranch_scc1 W_NOLN1
  s_cmp_eq_u32 s52, 3
  s_cbranch_scc0 W_NOZ
  v_mov_b32 v4, 0
  s_mov_b64 exec, 1
  buffer_store_dword v4, off, s[48:51], s71 sc1
  buffer_store_dword v4, off, s[48:51], s72 sc1
  s_mov_b64 exec, -1
W_NOZ:
  s_waitcnt vmcnt(28)
  s_waitcnt lgkmcnt(0)
  s_barrier
  ds_read_b64_tr_b16 a[0:1], v113 offset:0
  ds_read_b64_tr_b16 a[2:3], v113 offset:1024
  ds_read_b64_tr_b16 a[128:129], v115 offset:4096
  ds_read_b64_tr_b16 a[130:131], v115 offset:5120
  ds_read_b64_tr_b16 a[4:5], v113 offset:8192
  ds_read_b64_tr_b16 a[6:7], v113 offset:9216
  ds_read_b64_tr_b16 a[132:133], v115 offset:12288
  ds_read_b64_tr_b16 a[134:135], v115 offset:13312
  s_waitcnt vmcnt(24)
  s_waitcnt lgkmcnt(0)
  s_barrier
  s_add_u32 m0, s74, 0
  s_mov_b32 s56, 2097152
  buffer_load_dwordx4 v112, s[16:19], s56 offen lds
  s_add_u32 m0, s74, 4096
  s_mov_b32 s56, 2097152
  buffer_load_dwordx4 v112, s[20:23], s56 offen lds
  s_add_u32 m0, s74, 8192
  s_mov_b32 s56, 2228224
  buffer_load_dwordx4 v112, s[16:19], s56 offen lds
  s_add_u32 m0, s74, 12288
  s_mov_b32 s56, 2228224
  buffer_load_dwordx4 v112, s[20:23], s56 offen lds
  ds_read_b64_tr_b16 a[8:9], v113 offset:16384
  ds_read_b64_tr_b16 a[10:11], v113 offset:17408
  ds_read_b64_tr_b16 a[136:137], v115 offset:20480
  ds_read_b64_tr_b16 a[138:139], v115 offset:21504
  ds_read_b64_tr_b16 a[12:13], v113 offset:24576
  ds_read_b64_tr_b16 a[14:15], v113 offset:25600
  ds_read_b64_tr_b16 a[140:141], v115 offset:28672
  ds_read_b64_tr_b16 a[142:143], v115 offset:29696
  s_waitcnt vmcnt(24)
  s_waitcnt lgkmcnt(0)
  s_barrier
  s_add_u32 m0, s74, 16384
  s_mov_b32 s56, 2359296
  buffer_load_dwordx4 v112, s[16:19], s56 offen lds
  s_add_u32 m0, s74, 20480
  s_mov_b32 s56, 2359296
  buffer_load_dwordx4 v112, s[20:23], s56 offen lds
  s_add_u32 m0, s74, 24576
  s_mov_b32 s56, 2490368
  buffer_load_dwordx4 v112, s[16:19], s56 offen lds
  s_add_u32 m0, s74, 28672
  s_mov_b32 s56, 2490368
  buffer_load_dwordx4 v112, s[20:23], s56 offen lds
  ds_read_b64_tr_b16 a[16:17], v113 offset:32768
  ds_read_b64_tr_b16 a[18:19], v113 offset:33792
  ds_read_b64_tr_b16 a[144:145], v115 offset:36864
  ds_read_b64_tr_b16 a[146:147], v115 offset:37888
  ds_read_b64_tr_b16 a[20:21], v113 offset:40960
  ds_read_b64_tr_b16 a[22:23], v113 offset:41984
  ds_read_b64_tr_b16 a[148:149], v115 offset:45056
  ds_read_b64_tr_b16 a[150:151], v115 offset:46080
  s_waitcnt vmcnt(24)
  s_waitcnt lgkmcnt(0)
  s_barrier
  s_add_u32 m0, s74, 32768
  s_mov_b32 s56, 2621440
  buffer_load_dwordx4 v112, s[16:19], s56 offen lds
  s_add_u32 m0, s74, 36864
  s_mov_b32 s56, 2621440
  buffer_load_dwordx4 v112, s[20:23], s56 offen lds
  s_add_u32 m0, s74, 40960
  s_mov_b32 s56, 2752512
  buffer_load_dwordx4 v112, s[16:19], s56 offen lds
  s_add_u32 m0, s74, 45056
  s_mov_b32 s56, 2752512
  buffer_load_dwordx4 v112, s[20:23], s56 offen lds
  ds_read_b64_tr_b16 a[24:25], v113 offset:49152
  ds_read_b64_tr_b16 a[26:27], v113 offset:50176
  ds_read_b64_tr_b16 a[152:153], v115 offset:53248
  ds_read_b64_tr_b16 a[154:155], v115 offset:54272
  ds_read_b64_tr_b16 a[28:29], v113 offset:57344
  ds_read_b64_tr_b16 a[30:31], v113 offset:58368
  ds_read_b64_tr_b16 a[156:157], v115 offset:61440
  ds_read_b64_tr_b16 a[158:159], v115 offset:62464
  s_waitcnt vmcnt(24)
  s_waitcnt lgkmcnt(0)
  s_barrier
  s_add_u32 m0, s74, 49152
  s_mov_b32 s56, 2883584
  buffer_load_dwordx4 v112, s[16:19], s56 offen lds
  s_add_u32 m0, s74, 53248
  s_mov_b32 s56, 2883584
  buffer_load_dwordx4 v112, s[20:23], s56 offen lds
  s_add_u32 m0, s74, 57344
  s_mov_b32 s56, 3014656
  buffer_load_dwordx4 v112, s[16:19], s56 offen lds
  s_add_u32 m0, s74, 61440
  s_mov_b32 s56, 3014656
  buffer_load_dwordx4 v112, s[20:23], s56 offen lds
  ds_read_b64_tr_b16 a[32:33], v114 offset:0
  ds_read_b64_tr_b16 a[34:35], v114 offset:1024
  ds_read_b64_tr_b16 a[160:161], v116 offset:4096
  ds_read_b64_tr_b16 a[162:163], v116 offset:5120
  ds_read_b64_tr_b16 a[36:37], v114 offset:8192
  ds_read_b64_tr_b16 a[38:39], v114 offset:9216
  ds_read_b64_tr_b16 a[164:165], v116 offset:12288
  ds_read_b64_tr_b16 a[166:167], v116 offset:13312
  s_waitcnt vmcnt(24)
  s_waitcnt lgkmcnt(0)
  s_barrier
  s_add_u32 m0, s74, 65536
  s_mov_b32 s56, 3145728
  buffer_load_dwordx4 v112, s[16:19], s56 offen lds
  s_add_u32 m0, s74, 69632
  s_mov_b32 s56, 3145728
  buffer_load_dwordx4 v112, s[20:23], s56 offen lds
  s_add_u32 m0, s74, 73728
  s_mov_b32 s56, 3276800
  buffer_load_dwordx4 v112, s[16:19], s56 offen lds
  s_add_u32 m0, s74, 77824
  s_mov_b32 s56, 3276800
  buffer_load_dwordx4 v112, s[20:23], s56 offen lds
  ds_read_b64_tr_b16 a[40:41], v114 offset:16384
  ds_read_b64_tr_b16 a[42:43], v114 offset:17408
  ds_read_b64_tr_b16 a[168:169], v116 offset:20480
  ds_read_b64_tr_b16 a[170:171], v116 offset:21504
  ds_read_b64_tr_b16 a[44:45], v114 offset:24576
  ds_read_b64_tr_b16 a[46:47], v114 offset:25600
  ds_read_b64_tr_b16 a[172:173], v116 offset:28672
  ds_read_b64_tr_b16 a[174:175], v116 offset:29696
  s_waitcnt vmcnt(24)
  s_waitcnt lgkmcnt(0)
  s_barrier
  s_add_u32 m0, s74, 81920
  s_mov_b32 s56, 3407872
  buffer_load_dwordx4 v112, s[16:19], s56 offen lds
  s_add_u32 m0, s74, 86016
  s_mov_b32 s56, 3407872
  buffer_load_dwordx4 v112, s[20:23], s56 offen lds
  s_add_u32 m0, s74, 90112
  s_mov_b32 s56, 3538944
  buffer_load_dwordx4 v112, s[16:19], s56 offen lds
  s_add_u32 m0, s74, 94208
  s_mov_b32 s56, 3538944
  buffer_load_dwordx4 v112, s[20:23], s56 offen lds
  ds_read_b64_tr_b16 a[48:49], v114 offset:32768
  ds_read_b64_tr_b16 a[50:51], v114 offset:33792
  ds_read_b64_tr_b16 a[176:177], v116 offset:36864
  ds_read_b64_tr_b16 a[178:179], v116 offset:37888
  ds_read_b64_tr_b16 a[52:53], v114 offset:40960
  ds_read_b64_tr_b16 a[54:55], v114 offset:41984
  ds_read_b64_tr_b16 a[180:181], v116 offset:45056
  ds_read_b64_tr_b16 a[182:183], v116 offset:46080
  s_waitcnt vmcnt(24)
  s_waitcnt lgkmcnt(0)
  s_barrier
  s_add_u32 m0, s74, 98304
  s_mov_b32 s56, 3670016
  buffer_load_dwordx4 v112, s[16:19], s56 offen lds
  s_add_u32 m0, s74, 102400
  s_mov_b32 s56, 3670016
  buffer_load_dwordx4 v112, s[20:23], s56 offen lds
  s_add_u32 m0, s74, 106496
  s_mov_b32 s56, 3801088
  buffer_load_dwordx4 v112, s[16:19], s56 offen lds
  s_add_u32 m0, s74, 110592
  s_mov_b32 s56, 3801088
  buffer_load_dwordx4 v112, s[20:23], s56 offen lds
  ds_read_b64_tr_b16 a[56:57], v114 offset:49152
  ds_read_b64_tr_b16 a[58:59], v114 offset:50176
  ds_read_b64_tr_b16 a[184:185], v116 offset:53248
  ds_read_b64_tr_b16 a[186:187], v116 offset:54272
  ds_read_b64_tr_b16 a[60:61], v114 offset:57344
  ds_read_b64_tr_b16 a[62:63], v114 offset:58368
  ds_read_b64_tr_b16 a[188:189], v116 offset:61440
  ds_read_b64_tr_b16 a[190:191], v116 offset:62464
  s_waitcnt vmcnt(24)
  s_waitcnt lgkmcnt(0)
  s_barrier
  s_add_u32 m0, s74, 114688
  s_mov_b32 s56, 3932160
  buffer_load_dwordx4 v112, s[16:19], s56 offen lds
  s_add_u32 m0, s74, 118784
  s_mov_b32 s56, 3932160
  buffer_load_dwordx4 v112, s[20:23], s56 offen lds
  s_add_u32 m0, s74, 122880
  s_mov_b32 s56, 4063232
  buffer_load_dwordx4 v112, s[16:19], s56 offen lds
  s_add_u32 m0, s74, 126976
  s_mov_b32 s56, 4063232
  buffer_load_dwordx4 v112, s[20:23], s56 offen lds
  ds_read_b64_tr_b16 a[64:65], v113 offset:0
  ds_read_b64_tr_b16 a[66:67], v113 offset:1024
  ds_read_b64_tr_b16 a[192:193], v115 offset:4096
  ds_read_b64_tr_b16 a[194:195], v115 offset:5120
  ds_read_b64_tr_b16 a[68:69], v113 offset:8192
  ds_read_b64_tr_b16 a[70:71], v113 offset:9216
  ds_read_b64_tr_b16 a[196:197], v115 offset:12288
  ds_read_b64_tr_b16 a[198:199], v115 offset:13312
  s_cmp_eq_u32 s52, 3
  s_cbranch_scc0 W_NOA
  s_mul_i32 s57, s55, s55
  s_lshl_b32 s57, s57, 8
  s_add_u32 s57, s57, s55
  s_add_u32 s57, s57, 0x1000000
  v_mov_b32 v4, s57
  s_lshl_b32 s57, s54, 2
  s_mov_b64 exec, 1
  buffer_atomic_add v4, off, s[44:47], s57 offset:128
  s_mov_b64 exec, -1
  s_branch W_NOLN1
W_NOA:
  buffer_load_dword v117, off, s[4:7], 0
  s_cmp_eq_u32 s69, 0
  s_cbranch_scc1 W_NOLN1
  s_mov_b32 s73, 2
  v_lshlrev_b32 v48, 16, v128
  v_and_b32 v49, 0xffff0000, v128
  v_lshlrev_b32 v50, 16, v129
  v_and_b32 v51, 0xffff0000, v129
  v_lshlrev_b32 v52, 16, v130
  v_and_b32 v53, 0xffff0000, v130
  v_lshlrev_b32 v54, 16, v131
  v_and_b32 v55, 0xffff0000, v131
  v_lshlrev_b32 v56, 16, v132
  v_and_b32 v57, 0xffff0000, v132
  v_lshlrev_b32 v58, 16, v133
  v_and_b32 v59, 0xffff0000, v133
  v_lshlrev_b32 v60, 16, v134
  v_and_b32 v61, 0xffff0000, v134
  v_lshlrev_b32 v62, 16, v135
  v_and_b32 v63, 0xffff0000, v135
  v_lshlrev_b32 v64, 16, v136
  v_and_b32 v65, 0xffff0000, v136
  v_lshlrev_b32 v66, 16, v137
  v_and_b32 v67, 0xffff0000, v137
  v_lshlrev_b32 v68, 16, v138
  v_and_b32 v69, 0xffff0000, v138
  v_lshlrev_b32 v70, 16, v139
  v_and_b32 v71, 0xffff0000, v139
  v_lshlrev_b32 v72, 16, v140
  v_and_b32 v73, 0xffff0000, v140
  v_lshlrev_b32 v74, 16, v141
  v_and_b32 v75, 0xffff0000, v141
  v_lshlrev_b32 v76, 16, v142
  v_and_b32 v77, 0xffff0000, v142
  v_lshlrev_b32 v78, 16, v143
  v_and_b32 v79, 0xffff0000, v143
  v_lshlrev_b32 v80, 16, v144
  v_and_b32 v81, 0xffff0000, v144
  v_lshlrev_b32 v82, 16, v145
  v_and_b32 v83, 0xffff0000, v145
  v_lshlrev_b32 v84, 16, v146
  v_and_b32 v85, 0xffff0000, v146
  v_lshlrev_b32 v86, 16, v147
  v_and_b32 v87, 0xffff0000, v147
  v_lshlrev_b32 v88, 16, v148
  v_and_b32 v89, 0xffff0000, v148
  v_lshlrev_b32 v90, 16, v149
  v_and_b32 v91, 0xffff0000, v149
  v_lshlrev_b32 v92, 16, v150
  v_and_b32 v93, 0xffff0000, v150
  v_lshlrev_b32 v94, 16, v151
  v_and_b32 v95, 0xffff0000, v151
  v_lshlrev_b32 v96, 16, v152
  v_and_b32 v97, 0xffff0000, v152
  v_lshlrev_b32 v98, 16, v153
  v_and_b32 v99, 0xffff0000, v153
  v_lshlrev_b32 v100, 16, v154
  v_and_b32 v101, 0xffff0000, v154
  v_lshlrev_b32 v102, 16, v155
  v_and_b32 v103, 0xffff0000, v155
  v_lshlrev_b32 v104, 16, v156
  v_and_b32 v105, 0xffff0000, v156
  v_lshlrev_b32 v106, 16, v157
  v_and_b32 v107, 0xffff0000, v157
  v_lshlrev_b32 v108, 16, v158
  v_and_b32 v109, 0xffff0000, v158
  v_lshlrev_b32 v110, 16, v159
  v_and_b32 v111, 0xffff0000, v159
  s_branch W_LN
W_NOLN1:
  s_waitcnt vmcnt(25)
  s_waitcnt lgkmcnt(0)
  s_barrier
  ds_read_b64_tr_b16 a[72:73], v113 offset:16384
  ds_read_b64_tr_b16 a[74:75], v113 offset:17408
  ds_read_b64_tr_b16 a[200:201], v115 offset:20480
  ds_read_b64_tr_b16 a[202:203], v115 offset:21504
  ds_read_b64_tr_b16 a[76:77], v113 offset:24576
  ds_read_b64_tr_b16 a[78:79], v113 offset:25600
  ds_read_b64_tr_b16 a[204:205], v115 offset:28672
  ds_read_b64_tr_b16 a[206:207], v115 offset:29696
  s_waitcnt vmcnt(21)
  s_waitcnt lgkmcnt(0)
  s_barrier
  ds_read_b64_tr_b16 a[80:81], v113 offset:32768
  ds_read_b64_tr_b16 a[82:83], v113 offset:33792
  ds_read_b64_tr_b16 a[208:209], v115 offset:36864
  ds_read_b64_tr_b16 a[210:211], v115 offset:37888
  ds_read_b64_tr_b16 a[84:85], v113 offset:40960
  ds_read_b64_tr_b16 a[86:87], v113 offset:41984
  ds_read_b64_tr_b16 a[212:213], v115 offset:45056
  ds_read_b64_tr_b16 a[214:215], v115 offset:46080
  s_waitcnt vmcnt(17)
  s_waitcnt lgkmcnt(0)
  s_barrier
  ds_read_b64_tr_b16 a[88:89], v113 offset:49152
  ds_read_b64_tr_b16 a[90:91], v113 offset:50176
  ds_read_b64_tr_b16 a[216:217], v115 offset:53248
  ds_read_b64_tr_b16 a[218:219], v115 offset:54272
  ds_read_b64_tr_b16 a[92:93], v113 offset:57344
  ds_read_b64_tr_b16 a[94:95], v113 offset:58368
  ds_read_b64_tr_b16 a[220:221], v115 offset:61440
  ds_read_b64_tr_b16 a[222:223], v115 offset:62464
  s_waitcnt vmcnt(13)
  s_waitcnt lgkmcnt(0)
  s_barrier
  ds_read_b64_tr_b16 a[96:97], v114 offset:0
  ds_read_b64_tr_b16 a[98:99], v114 offset:1024
  ds_read_b64_tr_b16 a[224:225], v116 offset:4096
  ds_read_b64_tr_b16 a[226:227], v116 offset:5120
  ds_read_b64_tr_b16 a[100:101], v114 offset:8192
  ds_read_b64_tr_b16 a[102:103], v114 offset:9216
  ds_read_b64_tr_b16 a[228:229], v116 offset:12288
  ds_read_b64_tr_b16 a[230:231], v116 offset:13312
  s_waitcnt vmcnt(9)
  s_waitcnt lgkmcnt(0)
  s_barrier
  ds_read_b64_tr_b16 a[104:105], v114 offset:16384
  ds_read_b64_tr_b16 a[106:107], v114 offset:17408
  ds_read_b64_tr_b16 a[232:233], v116 offset:20480
  ds_read_b64_tr_b16 a[234:235], v116 offset:21504
  ds_read_b64_tr_b16 a[108:109], v114 offset:24576
  ds_read_b64_tr_b16 a[110:111], v114 offset:25600
  ds_read_b64_tr_b16 a[236:237], v116 offset:28672
  ds_read_b64_tr_b16 a[238:239], v116 offset:29696
  s_waitcnt vmcnt(5)
  s_waitcnt lgkmcnt(0)
  s_barrier
  ds_read_b64_tr_b16 a[112:113], v114 offset:32768
  ds_read_b64_tr_b16 a[114:115], v114 offset:33792
  ds_read_b64_tr_b16 a[240:241], v116 offset:36864
  ds_read_b64_tr_b16 a[242:243], v116 offset:37888
  ds_read_b64_tr_b16 a[116:117], v114 offset:40960
  ds_read_b64_tr_b16 a[118:119], v114 offset:41984
  ds_read_b64_tr_b16 a[244:245], v116 offset:45056
  ds_read_b64_tr_b16 a[246:247], v116 offset:46080
  s_waitcnt vmcnt(1)
  s_waitcnt lgkmcnt(0)
  s_barrier
  ds_read_b64_tr_b16 a[120:121], v114 offset:49152
  ds_read_b64_tr_b16 a[122:123], v114 offset:50176
  ds_read_b64_tr_b16 a[248:249], v116 offset:53248
  ds_read_b64_tr_b16 a[250:251], v116 offset:54272
  ds_read_b64_tr_b16 a[124:125], v114 offset:57344
  ds_read_b64_tr_b16 a[126:127], v114 offset:58368
  ds_read_b64_tr_b16 a[252:253], v116 offset:61440
  ds_read_b64_tr_b16 a[254:255], v116 offset:62464
  s_waitcnt lgkmcnt(0)
  s_barrier
  v_lshlrev_b32 v4, 4, v1
  v_and_b32 v4, 255, v4
  v_lshrrev_b32 v5, 5, v1
  v_lshl_add_u32 v4, v5, 8, v4
  v_bfe_u32 v5, v1, 4, 1
  v_lshl_add_u32 v11, v5, 10, v4
  s_lshl_b32 s70, s53, 13
  s_lshl_b32 s56, s52, 11
  s_add_u32 s75, s70, s56
  v_lshlrev_b32 v12, 13, v5
  v_lshrrev_b32 v5, 5, v1
  v_lshl_add_u32 v12, v5, 8, v12
  v_bfe_u32 v5, v1, 1, 1
  v_lshl_add_u32 v12, v5, 12, v12
  v_bfe_u32 v5, v1, 2, 2
  v_lshl_add_u32 v12, v5, 5, v12
  v_and_b32 v5, 1, v1
  v_lshl_add_u32 v12, v5, 4, v12
  s_and_b32 s56, s52, 1
  s_lshl_b32 s56, s56, 10
  s_lshr_b32 s57, s52, 1
  s_lshl_b32 s57, s57, 7
  s_add_u32 s56, s56, s57
  v_add_u32 v12, s56, v12
  v_mov_b32 v96, -1
  v_mov_b32 v97, -1
  v_mov_b32 v98, -1
  v_mov_b32 v99, -1
  s_mov_b32 s66, 1
  s_mov_b32 s67, s64
  s_mov_b32 s69, 0
  v_add_u32 v13, 131072, v2
  ds_read_b128 v[16:19], v13 offset:0
  ds_read_b128 v[20:23], v13 offset:1024
  ds_read_b128 v[24:27], v13 offset:2048
  ds_read_b128 v[28:31], v13 offset:3072
  ds_read_b128 v[32:35], v13 offset:4096
  ds_read_b128 v[36:39], v13 offset:5120
  ds_read_b128 v[40:43], v13 offset:6144
  ds_read_b128 v[44:47], v13 offset:7168
  s_waitcnt lgkmcnt(7)
  v_mfma_f32_32x32x16_bf16 v[48:63], a[0:3], v[16:19], 0
  v_mfma_f32_32x32x16_bf16 v[64:79], v[16:19], a[128:131], 0
  ds_read_b128 v[16:19], v13 offset:8192
  s_waitcnt lgkmcnt(7)
  v_mfma_f32_32x32x16_bf16 v[48:63], a[4:7], v[20:23], v[48:63]
  v_mfma_f32_32x32x16_bf16 v[64:79], v[20:23], a[132:135], v[64:79]
  ds_read_b128 v[20:23], v13 offset:9216
  s_waitcnt lgkmcnt(7)
  v_mfma_f32_32x32x16_bf16 v[48:63], a[8:11], v[24:27], v[48:63]
  v_mfma_f32_32x32x16_bf16 v[64:79], v[24:27], a[136:139], v[64:79]
  ds_read_b128 v[24:27], v13 offset:10240
  s_waitcnt lgkmcnt(7)
  v_mfma_f32_32x32x16_bf16 v[48:63], a[12:15], v[28:31], v[48:63]
  v_mfma_f32_32x32x16_bf16 v[64:79], v[28:31], a[140:143], v[64:79]
  ds_read_b128 v[28:31], v13 offset:11264
  s_waitcnt lgkmcnt(7)
  v_mfma_f32_32x32x16_bf16 v[48:63], a[16:19], v[32:35], v[48:63]
  v_mfma_f32_32x32x16_bf16 v[64:79], v[32:35], a[144:147], v[64:79]
  ds_read_b128 v[32:35], v13 offset:12288
  s_waitcnt lgkmcnt(7)
  v_mfma_f32_32x32x16_bf16 v[48:63], a[20:23], v[36:39], v[48:63]
  v_mfma_f32_32x32x16_bf16 v[64:79], v[36:39], a[148:151], v[64:79]
  ds_read_b128 v[36:39], v13 offset:13312
  s_waitcnt lgkmcnt(7)
  v_mfma_f32_32x32x16_bf16 v[48:63], a[24:27], v[40:43], v[48:63]
  v_mfma_f32_32x32x16_bf16 v[64:79], v[40:43], a[152:155], v[64:79]
  ds_read_b128 v[40:43], v13 offset:14336
  s_waitcnt lgkmcnt(7)
  v_mfma_f32_32x32x16_bf16 v[48:63], a[28:31], v[44:47], v[48:63]
  v_mfma_f32_32x32x16_bf16 v[64:79], v[44:47], a[156:159], v[64:79]
  ds_read_b128 v[44:47], v13 offset:15360
  s_waitcnt lgkmcnt(7)
  v_mfma_f32_32x32x16_bf16 v[48:63], a[32:35], v[16:19], v[48:63]
  v_mfma_f32_32x32x16_bf16 v[64:79], v[16:19], a[160:163], v[64:79]
  ds_read_b128 v[16:19], v13 offset:16384
  s_waitcnt lgkmcnt(7)
  v_mfma_f32_32x32x16_bf16 v[48:63], a[36:39], v[20:23], v[48:63]
  v_mfma_f32_32x32x16_bf16 v[64:79], v[20:23], a[164:167], v[64:79]
  ds_read_b128 v[20:23], v13 offset:17408
  s_waitcnt lgkmcnt(7)
  v_mfma_f32_32x32x16_bf16 v[48:63], a[40:43], v[24:27], v[48:63]
  v_mfma_f32_32x32x16_bf16 v[64:79], v[24:27], a[168:171], v[64:79]
  ds_read_b128 v[24:27], v13 offset:18432
  s_waitcnt lgkmcnt(7)
  v_mfma_f32_32x32x16_bf16 v[48:63], a[44:47], v[28:31], v[48:63]
  v_mfma_f32_32x32x16_bf16 v[64:79], v[28:31], a[172:175], v[64:79]
  ds_read_b128 v[28:31], v13 offset:19456
  s_waitcnt lgkmcnt(7)
  v_mfma_f32_32x32x16_bf16 v[48:63], a[48:51], v[32:35], v[48:63]
  v_mfma_f32_32x32x16_bf16 v[64:79], v[32:35], a[176:179], v[64:79]
  ds_read_b128 v[32:35], v13 offset:20480
  s_waitcnt lgkmcnt(7)
  v_mfma_f32_32x32x16_bf16 v[48:63], a[52:55], v[36:39], v[48:63]
  v_mfma_f32_32x32x16_bf16 v[64:79], v[36:39], a[180:183], v[64:79]
  ds_read_b128 v[36:39], v13 offset:21504
  s_waitcnt lgkmcnt(7)
  v_mfma_f32_32x32x16_bf16 v[48:63], a[56:59], v[40:43], v[48:63]
  v_mfma_f32_32x32x16_bf16 v[64:79], v[40:43], a[184:187], v[64:79]
  ds_read_b128 v[40:43], v13 offset:22528
  s_waitcnt lgkmcnt(7)
  v_mfma_f32_32x32x16_bf16 v[48:63], a[60:63], v[44:47], v[48:63]
  v_mfma_f32_32x32x16_bf16 v[64:79], v[44:47], a[188:191], v[64:79]
  ds_read_b128 v[44:47], v13 offset:23552
  s_waitcnt lgkmcnt(7)
  v_mfma_f32_32x32x16_bf16 v[48:63], a[64:67], v[16:19], v[48:63]
  v_mfma_f32_32x32x16_bf16 v[64:79], v[16:19], a[192:195], v[64:79]
  ds_read_b128 v[16:19], v13 offset:24576
  s_waitcnt lgkmcnt(7)
  v_mfma_f32_32x32x16_bf16 v[48:63], a[68:71], v[20:23], v[48:63]
  v_mfma_f32_32x32x16_bf16 v[64:79], v[20:23], a[196:199], v[64:79]
  ds_read_b128 v[20:23], v13 offset:25600
  s_waitcnt lgkmcnt(7)
  v_mfma_f32_32x32x16_bf16 v[48:63], a[72:75], v[24:27], v[48:63]
  v_mfma_f32_32x32x16_bf16 v[64:79], v[24:27], a[200:203], v[64:79]
  ds_read_b128 v[24:27], v13 offset:26624
  s_waitcnt lgkmcnt(7)
  v_mfma_f32_32x32x16_bf16 v[48:63], a[76:79], v[28:31], v[48:63]
  v_mfma_f32_32x32x16_bf16 v[64:79], v[28:31], a[204:207], v[64:79]
  ds_read_b128 v[28:31], v13 offset:27648
  s_waitcnt lgkmcnt(7)
  v_mfma_f32_32x32x16_bf16 v[48:63], a[80:83], v[32:35], v[48:63]
  v_mfma_f32_32x32x16_bf16 v[64:79], v[32:35], a[208:211], v[64:79]
  ds_read_b128 v[32:35], v13 offset:28672
  s_waitcnt lgkmcnt(7)
  v_mfma_f32_32x32x16_bf16 v[48:63], a[84:87], v[36:39], v[48:63]
  v_mfma_f32_32x32x16_bf16 v[64:79], v[36:39], a[212:215], v[64:79]
  ds_read_b128 v[36:39], v13 offset:29696
  s_waitcnt lgkmcnt(7)
  v_mfma_f32_32x32x16_bf16 v[48:63], a[88:91], v[40:43], v[48:63]
  v_mfma_f32_32x32x16_bf16 v[64:79], v[40:43], a[216:219], v[64:79]
  ds_read_b128 v[40:43], v13 offset:30720
  s_waitcnt lgkmcnt(7)
  v_mfma_f32_32x32x16_bf16 v[48:63], a[92:95], v[44:47], v[48:63]
  v_mfma_f32_32x32x16_bf16 v[64:79], v[44:47], a[220:223], v[64:79]
  ds_read_b128 v[44:47], v13 offset:31744
  s_waitcnt lgkmcnt(7)
  v_mfma_f32_32x32x16_bf16 v[48:63], a[96:99], v[16:19], v[48:63]
  v_mfma_f32_32x32x16_bf16 v[64:79], v[16:19], a[224:227], v[64:79]
  s_waitcnt lgkmcnt(6)
  v_mfma_f32_32x32x16_bf16 v[48:63], a[100:103], v[20:23], v[48:63]
  v_mfma_f32_32x32x16_bf16 v[64:79], v[20:23], a[228:231], v[64:79]
  s_waitcnt lgkmcnt(5)
  v_mfma_f32_32x32x16_bf16 v[48:63], a[104:107], v[24:27], v[48:63]
  v_mfma_f32_32x32x16_bf16 v[64:79], v[24:27], a[232:235], v[64:79]
  s_waitcnt lgkmcnt(4)
  v_mfma_f32_32x32x16_bf16 v[48:63], a[108:111], v[28:31], v[48:63]
  v_mfma_f32_32x32x16_bf16 v[64:79], v[28:31], a[236:239], v[64:79]
  s_waitcnt lgkmcnt(3)
  v_mfma_f32_32x32x16_bf16 v[48:63], a[112:115], v[32:35], v[48:63]
  v_mfma_f32_32x32x16_bf16 v[64:79], v[32:35], a[240:243], v[64:79]
  s_waitcnt lgkmcnt(2)
  v_mfma_f32_32x32x16_bf16 v[48:63], a[116:119], v[36:39], v[48:63]
  v_mfma_f32_32x32x16_bf16 v[64:79], v[36:39], a[244:247], v[64:79]
  s_waitcnt lgkmcnt(1)
  v_mfma_f32_32x32x16_bf16 v[48:63], a[120:123], v[40:43], v[48:63]
  v_mfma_f32_32x32x16_bf16 v[64:79], v[40:43], a[248:251], v[64:79]
  s_waitcnt lgkmcnt(0)
  v_mfma_f32_32x32x16_bf16 v[48:63], a[124:127], v[44:47], v[48:63]
  v_mfma_f32_32x32x16_bf16 v[64:79], v[44:47], a[252:255], v[64:79]
  s_lshl_b32 s56, s67, 18
  s_add_u32 s56, s56, s75
  s_lshr_b32 s57, s56, 1
  s_add_u32 s57, s57, 53477376
  buffer_store_dwordx4 v[96:99], v2, s[48:51], s57 offen sc1
  s_lshl_b32 s56, s56, 1
  s_add_u32 s56, s56, 2097152
  s_and_b32 s57, s56, 0xffffc000
  s_nop 2
  v_cvt_pk_bf16_f32 v80, v48, v49
  v_cvt_pk_bf16_f32 v81, v50, v51
  v_cvt_pk_bf16_f32 v82, v52, v53
  v_cvt_pk_bf16_f32 v83, v54, v55
  v_cvt_pk_bf16_f32 v84, v56, v57
  v_cvt_pk_bf16_f32 v85, v58, v59
  v_cvt_pk_bf16_f32 v86, v60, v61
  v_cvt_pk_bf16_f32 v87, v62, v63
  buffer_store_dwordx4 v[80:83], v12, s[48:51], s57 offen sc1
  buffer_store_dwordx4 v[84:87], v12, s[48:51], s57 offen offset:512 sc1
  v_cvt_pk_bf16_f32 v88, v64, v65
  v_cvt_pk_bf16_f32 v89, v66, v67
  v_cvt_pk_bf16_f32 v90, v72, v73
  v_cvt_pk_bf16_f32 v91, v74, v75
  v_cvt_pk_bf16_f32 v92, v68, v69
  v_cvt_pk_bf16_f32 v93, v70, v71
  v_cvt_pk_bf16_f32 v94, v76, v77
  v_cvt_pk_bf16_f32 v95, v78, v79
  buffer_store_dwordx4 v[88:91], v11, s[48:51], s56 offen offset:2048 sc1
  buffer_store_dwordx4 v[92:95], v11, s[48:51], s56 offen offset:2560 sc1
  s_add_u32 s67, s67, 7
  s_waitcnt vmcnt(0)
  s_barrier
  s_cmp_eq_u32 s52, 0
  s_cbranch_scc0 P1_NOPUBF
  v_mov_b32 v4, s66
  s_mov_b64 exec, 1
  buffer_store_dword v4, off, s[48:51], s71 sc1
  s_mov_b64 exec, -1
P1_NOPUBF:
  s_cmp_eq_u32 s52, 1
  s_cbranch_scc0 W_LNOK
  s_lshl_b32 s57, s54, 2
W_LNP:
  buffer_load_dword v4, off, s[44:47], s57 offset:128 sc1
  s_sub_u32 s60, s60, 1
  s_cbranch_scc1 EXIT
  s_waitcnt vmcnt(0)
  v_cmp_gt_u32 vcc, 0x20000000, v4
  s_cbranch_vccnz W_LNP
W_LNOK:
  s_barrier
  s_lshl_b32 s56, s67, 15
  s_lshl_b32 s57, s52, 13
  s_add_u32 s56, s56, s57
  s_add_u32 m0, s69, s57
  s_add_u32 s58, s56, 4096
  buffer_load_dwordx4 v2, s[48:51], s56 offen offset:0 sc1 lds
  buffer_load_dwordx4 v2, s[48:51], s56 offen offset:1024 sc1 lds
  buffer_load_dwordx4 v2, s[48:51], s56 offen offset:2048 sc1 lds
  buffer_load_dwordx4 v2, s[48:51], s56 offen offset:3072 sc1 lds
  s_add_u32 m0, m0, 4096
  s_nop 0
  buffer_load_dwordx4 v2, s[48:51], s58 offen offset:0 sc1 lds
  buffer_load_dwordx4 v2, s[48:51], s58 offen offset:1024 sc1 lds
  buffer_load_dwordx4 v2, s[48:51], s58 offen offset:2048 sc1 lds
  buffer_load_dwordx4 v2, s[48:51], s58 offen offset:3072 sc1 lds
  s_waitcnt vmcnt(0)
P1_LOOP:
  s_barrier
  s_sub_u32 s56, s66, 1
  s_max_i32 s56, s56, 1
  s_cmp_eq_u32 s52, 0
  s_cbranch_scc0 P1_NOPUBA
  v_mov_b32 v4, s56
  s_mov_b64 exec, 1
  buffer_store_dword v4, off, s[48:51], s71 sc1
  s_mov_b64 exec, -1
P1_NOPUBA:
  v_add_u32 v13, s69, v2
  s_xor_b32 s69, s69, 0x8000
  s_add_u32 s66, s66, 1
  s_cmp_eq_u32 s66, s65
  s_cbranch_scc1 P1_NOPF
P1_PF:
  s_add_u32 s59, s67, 7
  s_lshl_b32 s56, s59, 15
  s_lshl_b32 s57, s52, 13
  s_add_u32 s56, s56, s57
  s_add_u32 m0, s69, s57
  s_add_u32 s58, s56, 4096
  buffer_load_dwordx4 v2, s[48:51], s56 offen offset:0 sc1 lds
  buffer_load_dwordx4 v2, s[48:51], s56 offen offset:1024 sc1 lds
  buffer_load_dwordx4 v2, s[48:51], s56 offen offset:2048 sc1 lds
  buffer_load_dwordx4 v2, s[48:51], s56 offen offset:3072 sc1 lds
  s_add_u32 m0, m0, 4096
  s_nop 0
  buffer_load_dwordx4 v2, s[48:51], s58 offen offset:0 sc1 lds
  buffer_load_dwordx4 v2, s[48:51], s58 offen offset:1024 sc1 lds
  buffer_load_dwordx4 v2, s[48:51], s58 offen offset:2048 sc1 lds
  buffer_load_dwordx4 v2, s[48:51], s58 offen offset:3072 sc1 lds
P1_NOPF:
  ds_read_b128 v[16:19], v13 offset:0
  ds_read_b128 v[20:23], v13 offset:1024
  ds_read_b128 v[24:27], v13 offset:2048
  ds_read_b128 v[28:31], v13 offset:3072
  ds_read_b128 v[32:35], v13 offset:4096
  ds_read_b128 v[36:39], v13 offset:5120
  ds_read_b128 v[40:43], v13 offset:6144
  ds_read_b128 v[44:47], v13 offset:7168
  s_waitcnt lgkmcnt(7)
  v_mfma_f32_32x32x16_bf16 v[48:63], a[0:3], v[16:19], 0
  v_mfma_f32_32x32x16_bf16 v[64:79], v[16:19], a[128:131], 0
  ds_read_b128 v[16:19], v13 offset:8192
  s_waitcnt lgkmcnt(7)
  v_mfma_f32_32x32x16_bf16 v[48:63], a[4:7], v[20:23], v[48:63]
  v_mfma_f32_32x32x16_bf16 v[64:79], v[20:23], a[132:135], v[64:79]
  ds_read_b128 v[20:23], v13 offset:9216
  s_waitcnt lgkmcnt(7)
  v_mfma_f32_32x32x16_bf16 v[48:63], a[8:11], v[24:27], v[48:63]
  v_mfma_f32_32x32x16_bf16 v[64:79], v[24:27], a[136:139], v[64:79]
  ds_read_b128 v[24:27], v13 offset:10240
  s_waitcnt lgkmcnt(7)
  v_mfma_f32_32x32x16_bf16 v[48:63], a[12:15], v[28:31], v[48:63]
  v_mfma_f32_32x32x16_bf16 v[64:79], v[28:31], a[140:143], v[64:79]
  ds_read_b128 v[28:31], v13 offset:11264
  s_waitcnt lgkmcnt(7)
  v_mfma_f32_32x32x16_bf16 v[48:63], a[16:19], v[32:35], v[48:63]
  v_mfma_f32_32x32x16_bf16 v[64:79], v[32:35], a[144:147], v[64:79]
  ds_read_b128 v[32:35], v13 offset:12288
  s_waitcnt lgkmcnt(7)
  v_mfma_f32_32x32x16_bf16 v[48:63], a[20:23], v[36:39], v[48:63]
  v_mfma_f32_32x32x16_bf16 v[64:79], v[36:39], a[148:151], v[64:79]
  ds_read_b128 v[36:39], v13 offset:13312
  s_waitcnt lgkmcnt(7)
  v_mfma_f32_32x32x16_bf16 v[48:63], a[24:27], v[40:43], v[48:63]
  v_mfma_f32_32x32x16_bf16 v[64:79], v[40:43], a[152:155], v[64:79]
  ds_read_b128 v[40:43], v13 offset:14336
  s_waitcnt lgkmcnt(7)
  v_mfma_f32_32x32x16_bf16 v[48:63], a[28:31], v[44:47], v[48:63]
  v_mfma_f32_32x32x16_bf16 v[64:79], v[44:47], a[156:159], v[64:79]
  ds_read_b128 v[44:47], v13 offset:15360
  s_waitcnt lgkmcnt(7)
  v_mfma_f32_32x32x16_bf16 v[48:63], a[32:35], v[16:19], v[48:63]
  v_mfma_f32_32x32x16_bf16 v[64:79], v[16:19], a[160:163], v[64:79]
  ds_read_b128 v[16:19], v13 offset:16384
  s_waitcnt lgkmcnt(7)
  v_mfma_f32_32x32x16_bf16 v[48:63], a[36:39], v[20:23], v[48:63]
  v_mfma_f32_32x32x16_bf16 v[64:79], v[20:23], a[164:167], v[64:79]
  ds_read_b128 v[20:23], v13 offset:17408
  s_waitcnt lgkmcnt(7)
  v_mfma_f32_32x32x16_bf16 v[48:63], a[40:43], v[24:27], v[48:63]
  v_mfma_f32_32x32x16_bf16 v[64:79], v[24:27], a[168:171], v[64:79]
  ds_read_b128 v[24:27], v13 offset:18432
  s_waitcnt lgkmcnt(7)
  v_mfma_f32_32x32x16_bf16 v[48:63], a[44:47], v[28:31], v[48:63]
  v_mfma_f32_32x32x16_bf16 v[64:79], v[28:31], a[172:175], v[64:79]
  ds_read_b128 v[28:31], v13 offset:19456
  s_waitcnt lgkmcnt(7)
  v_mfma_f32_32x32x16_bf16 v[48:63], a[48:51], v[32:35], v[48:63]
  v_mfma_f32_32x32x16_bf16 v[64:79], v[32:35], a[176:179], v[64:79]
  ds_read_b128 v[32:35], v13 offset:20480
  s_waitcnt lgkmcnt(7)
  v_mfma_f32_32x32x16_bf16 v[48:63], a[52:55], v[36:39], v[48:63]
  v_mfma_f32_32x32x16_bf16 v[64:79], v[36:39], a[180:183], v[64:79]
  ds_read_b128 v[36:39], v13 offset:21504
  s_waitcnt lgkmcnt(7)
  v_mfma_f32_32x32x16_bf16 v[48:63], a[56:59], v[40:43], v[48:63]
  v_mfma_f32_32x32x16_bf16 v[64:79], v[40:43], a[184:187], v[64:79]
  ds_read_b128 v[40:43], v13 offset:22528
  s_waitcnt lgkmcnt(7)
  v_mfma_f32_32x32x16_bf16 v[48:63], a[60:63], v[44:47], v[48:63]
  v_mfma_f32_32x32x16_bf16 v[64:79], v[44:47], a[188:191], v[64:79]
  ds_read_b128 v[44:47], v13 offset:23552
  s_waitcnt lgkmcnt(7)
  v_mfma_f32_32x32x16_bf16 v[48:63], a[64:67], v[16:19], v[48:63]
  v_mfma_f32_32x32x16_bf16 v[64:79], v[16:19], a[192:195], v[64:79]
  ds_read_b128 v[16:19], v13 offset:24576
  s_waitcnt lgkmcnt(7)
  v_mfma_f32_32x32x16_bf16 v[48:63], a[68:71], v[20:23], v[48:63]
  v_mfma_f32_32x32x16_bf16 v[64:79], v[20:23], a[196:199], v[64:79]
  ds_read_b128 v[20:23], v13 offset:25600
  s_waitcnt lgkmcnt(7)
  v_mfma_f32_32x32x16_bf16 v[48:63], a[72:75], v[24:27], v[48:63]
  v_mfma_f32_32x32x16_bf16 v[64:79], v[24:27], a[200:203], v[64:79]
  ds_read_b128 v[24:27], v13 offset:26624
  s_waitcnt lgkmcnt(7)
  v_mfma_f32_32x32x16_bf16 v[48:63], a[76:79], v[28:31], v[48:63]
  v_mfma_f32_32x32x16_bf16 v[64:79], v[28:31], a[204:207], v[64:79]
  ds_read_b128 v[28:31], v13 offset:27648
  s_waitcnt lgkmcnt(7)
  v_mfma_f32_32x32x16_bf16 v[48:63], a[80:83], v[32:35], v[48:63]
  v_mfma_f32_32x32x16_bf16 v[64:79], v[32:35], a[208:211], v[64:79]
  ds_read_b128 v[32:35], v13 offset:28672
  s_waitcnt lgkmcnt(7)
  v_mfma_f32_32x32x16_bf16 v[48:63], a[84:87], v[36:39], v[48:63]
  v_mfma_f32_32x32x16_bf16 v[64:79], v[36:39], a[212:215], v[64:79]
  ds_read_b128 v[36:39], v13 offset:29696
  s_waitcnt lgkmcnt(7)
  v_mfma_f32_32x32x16_bf16 v[48:63], a[88:91], v[40:43], v[48:63]
  v_mfma_f32_32x32x16_bf16 v[64:79], v[40:43], a[216:219], v[64:79]
  ds_read_b128 v[40:43], v13 offset:30720
  s_waitcnt lgkmcnt(7)
  v_mfma_f32_32x32x16_bf16 v[48:63], a[92:95], v[44:47], v[48:63]
  v_mfma_f32_32x32x16_bf16 v[64:79], v[44:47], a[220:223], v[64:79]
  ds_read_b128 v[44:47], v13 offset:31744
  s_waitcnt lgkmcnt(7)
  v_mfma_f32_32x32x16_bf16 v[48:63], a[96:99], v[16:19], v[48:63]
  v_mfma_f32_32x32x16_bf16 v[64:79], v[16:19], a[224:227], v[64:79]
  s_waitcnt lgkmcnt(6)
  v_mfma_f32_32x32x16_bf16 v[48:63], a[100:103], v[20:23], v[48:63]
  v_mfma_f32_32x32x16_bf16 v[64:79], v[20:23], a[228:231], v[64:79]
  s_waitcnt lgkmcnt(5)
  v_mfma_f32_32x32x16_bf16 v[48:63], a[104:107], v[24:27], v[48:63]
  v_mfma_f32_32x32x16_bf16 v[64:79], v[24:27], a[232:235], v[64:79]
  s_waitcnt lgkmcnt(4)
  v_mfma_f32_32x32x16_bf16 v[48:63], a[108:111], v[28:31], v[48:63]
  v_mfma_f32_32x32x16_bf16 v[64:79], v[28:31], a[236:239], v[64:79]
  s_waitcnt lgkmcnt(3)
  v_mfma_f32_32x32x16_bf16 v[48:63], a[112:115], v[32:35], v[48:63]
  v_mfma_f32_32x32x16_bf16 v[64:79], v[32:35], a[240:243], v[64:79]
  s_waitcnt lgkmcnt(2)
  v_mfma_f32_32x32x16_bf16 v[48:63], a[116:119], v[36:39], v[48:63]
  v_mfma_f32_32x32x16_bf16 v[64:79], v[36:39], a[244:247], v[64:79]
  s_waitcnt lgkmcnt(1)
  v_mfma_f32_32x32x16_bf16 v[48:63], a[120:123], v[40:43], v[48:63]
  v_mfma_f32_32x32x16_bf16 v[64:79], v[40:43], a[248:251], v[64:79]
  s_waitcnt lgkmcnt(0)
  v_mfma_f32_32x32x16_bf16 v[48:63], a[124:127], v[44:47], v[48:63]
  v_mfma_f32_32x32x16_bf16 v[64:79], v[44:47], a[252:255], v[64:79]
  s_lshl_b32 s56, s67, 18
  s_add_u32 s56, s56, s75
  s_lshr_b32 s57, s56, 1
  s_add_u32 s57, s57, 53477376
  buffer_store_dwordx4 v[96:99], v2, s[48:51], s57 offen sc1
  s_lshl_b32 s56, s56, 1
  s_add_u32 s56, s56, 2097152
  s_and_b32 s57, s56, 0xffffc000
  s_nop 2
  v_cvt_pk_bf16_f32 v80, v48, v49
  v_cvt_pk_bf16_f32 v81, v50, v51
  v_cvt_pk_bf16_f32 v82, v52, v53
  v_cvt_pk_bf16_f32 v83, v54, v55
  v_cvt_pk_bf16_f32 v84, v56, v57
  v_cvt_pk_bf16_f32 v85, v58, v59
  v_cvt_pk_bf16_f32 v86, v60, v61
  v_cvt_pk_bf16_f32 v87, v62, v63
  buffer_store_dwordx4 v[80:83], v12, s[48:51], s57 offen sc1
  buffer_store_dwordx4 v[84:87], v12, s[48:51], s57 offen offset:512 sc1
  v_cvt_pk_bf16_f32 v88, v64, v65
  v_cvt_pk_bf16_f32 v89, v66, v67
  v_cvt_pk_bf16_f32 v90, v72, v73
  v_cvt_pk_bf16_f32 v91, v74, v75
  v_cvt_pk_bf16_f32 v92, v68, v69
  v_cvt_pk_bf16_f32 v93, v70, v71
  v_cvt_pk_bf16_f32 v94, v76, v77
  v_cvt_pk_bf16_f32 v95, v78, v79
  buffer_store_dwordx4 v[88:91], v11, s[48:51], s56 offen offset:2048 sc1
  buffer_store_dwordx4 v[92:95], v11, s[48:51], s56 offen offset:2560 sc1
  s_add_u32 s67, s67, 7
  s_cmp_eq_u32 s66, s65
  s_waitcnt vmcnt(5)
  s_cbranch_scc0 P1_LOOP
  s_waitcnt vmcnt(0)
  s_barrier
  s_cmp_eq_u32 s52, 0
  s_cbranch_scc0 P1_NOPUBB
  v_mov_b32 v4, s66
  s_mov_b64 exec, 1
  buffer_store_dword v4, off, s[48:51], s71 sc1
  s_mov_b64 exec, -1
P1_NOPUBB:
  v_lshrrev_b32 v4, 1, v1
  v_mul_u32_u24 v14, 3584, v4
  v_and_b32 v5, 1, v1
  v_lshl_add_u32 v14, v5, 4, v14
  s_lshl_b32 s56, s53, 7
  s_lshl_b32 s57, s52, 5
  s_add_u32 s56, s56, s57
  v_add_u32 v14, s56, v14
  v_lshlrev_b32 v15, 4, v5
  v_bfe_u32 v5, v1, 1, 1
  v_lshl_add_u32 v15, v5, 3, v15
  v_bfe_u32 v5, v1, 2, 2
  v_lshl_add_u32 v15, v5, 5, v15
  v_lshrrev_b32 v5, 5, v1
  v_lshl_add_u32 v15, v5, 8, v15
  v_bfe_u32 v4, v1, 4, 1
  v_lshl_add_u32 v15, v4, 10, v15
  v_add_u32 v15, s68, v15
  v_lshlrev_b32 v10, 16, v4
  v_lshl_add_u32 v10, v5, 8, v10
  v_and_b32 v5, 15, v1
  v_lshl_add_u32 v10, v5, 4, v10
  s_lshl_b32 s56, s56, 4
  v_add_u32 v10, s56, v10
  s_add_u32 m0, s68, 0
  s_mov_b32 s56, 0
  buffer_load_dwordx4 v8, s[12:15], s56 offen lds
  s_add_u32 m0, s68, 1024
  s_mov_b32 s56, 131072
  buffer_load_dwordx4 v8, s[12:15], s56 offen lds
  s_add_u32 m0, s68, 2048
  s_mov_b32 s56, 0
  buffer_load_dwordx4 v14, s[28:31], s56 offen lds
  s_add_u32 m0, s68, 3072
  s_mov_b32 s56, 0
  buffer_load_dwordx4 v14, s[32:35], s56 offen lds
  s_add_u32 m0, s68, 4096
  s_mov_b32 s56, 262144
  buffer_load_dwordx4 v8, s[12:15], s56 offen lds
  s_add_u32 m0, s68, 5120
  s_mov_b32 s56, 393216
  buffer_load_dwordx4 v8, s[12:15], s56 offen lds
  s_add_u32 m0, s68, 6144
  s_mov_b32 s56, 114688
  buffer_load_dwordx4 v14, s[28:31], s56 offen lds
  s_add_u32 m0, s68, 7168
  s_mov_b32 s56, 114688
  buffer_load_dwordx4 v14, s[32:35], s56 offen lds
  s_add_u32 m0, s68, 8192
  s_mov_b32 s56, 524288
  buffer_load_dwordx4 v8, s[12:15], s56 offen lds
  s_add_u32 m0, s68, 9216
  s_mov_b32 s56, 655360
  buffer_load_dwordx4 v8, s[12:15], s56 offen lds
  s_add_u32 m0, s68, 10240
  s_mov_b32 s56, 229376
  buffer_load_dwordx4 v14, s[28:31], s56 offen lds
  s_add_u32 m0, s68, 11264
  s_mov_b32 s56, 229376
  buffer_load_dwordx4 v14, s[32:35], s56 offen lds
  s_add_u32 m0, s68, 12288
  s_mov_b32 s56, 786432
  buffer_load_dwordx4 v8, s[12:15], s56 offen lds
  s_add_u32 m0, s68, 13312
  s_mov_b32 s56, 917504
  buffer_load_dwordx4 v8, s[12:15], s56 offen lds
  s_add_u32 m0, s68, 14336
  s_mov_b32 s56, 344064
  buffer_load_dwordx4 v14, s[28:31], s56 offen lds
  s_add_u32 m0, s68, 15360
  s_mov_b32 s56, 344064
  buffer_load_dwordx4 v14, s[32:35], s56 offen lds
  s_add_u32 m0, s68, 16384
  s_mov_b32 s56, 1048576
  buffer_load_dwordx4 v8, s[12:15], s56 offen lds
  s_add_u32 m0, s68, 17408
  s_mov_b32 s56, 1179648
  buffer_load_dwordx4 v8, s[12:15], s56 offen lds
  s_add_u32 m0, s68, 18432
  s_mov_b32 s56, 458752
  buffer_load_dwordx4 v14, s[28:31], s56 offen lds
  s_add_u32 m0, s68, 19456
  s_mov_b32 s56, 458752
  buffer_load_dwordx4 v14, s[32:35], s56 offen lds
  s_add_u32 m0, s68, 20480
  s_mov_b32 s56, 1310720
  buffer_load_dwordx4 v8, s[12:15], s56 offen lds
  s_add_u32 m0, s68, 21504
  s_mov_b32 s56, 1441792
  buffer_load_dwordx4 v8, s[12:15], s56 offen lds
  s_add_u32 m0, s68, 22528
  s_mov_b32 s56, 573440
  buffer_load_dwordx4 v14, s[28:31], s56 offen lds
  s_add_u32 m0, s68, 23552
  s_mov_b32 s56, 573440
  buffer_load_dwordx4 v14, s[32:35], s56 offen lds
  s_add_u32 m0, s68, 24576
  s_mov_b32 s56, 1572864
  buffer_load_dwordx4 v8, s[12:15], s56 offen lds
  s_add_u32 m0, s68, 25600
  s_mov_b32 s56, 1703936
  buffer_load_dwordx4 v8, s[12:15], s56 offen lds
  s_add_u32 m0, s68, 26624
  s_mov_b32 s56, 688128
  buffer_load_dwordx4 v14, s[28:31], s56 offen lds
  s_add_u32 m0, s68, 27648
  s_mov_b32 s56, 688128
  buffer_load_dwordx4 v14, s[32:35], s56 offen lds
  s_add_u32 m0, s68, 28672
  s_mov_b32 s56, 1835008
  buffer_load_dwordx4 v8, s[12:15], s56 offen lds
  s_add_u32 m0, s68, 29696
  s_mov_b32 s56, 1966080
  buffer_load_dwordx4 v8, s[12:15], s56 offen lds
  s_add_u32 m0, s68, 30720
  s_mov_b32 s56, 802816
  buffer_load_dwordx4 v14, s[28:31], s56 offen lds
  s_add_u32 m0, s68, 31744
  s_mov_b32 s56, 802816
  buffer_load_dwordx4 v14, s[32:35], s56 offen lds
  s_waitcnt vmcnt(28)
  ds_read_b64_tr_b16 a[0:1], v9 offset:0
  ds_read_b64_tr_b16 a[2:3], v9 offset:256
  ds_read_b64_tr_b16 a[4:5], v9 offset:1024
  ds_read_b64_tr_b16 a[6:7], v9 offset:1280
  ds_read_b64_tr_b16 a[128:129], v15 offset:2048
  ds_read_b64_tr_b16 a[130:131], v15 offset:2176
  ds_read_b64_tr_b16 a[132:133], v15 offset:2560
  ds_read_b64_tr_b16 a[134:135], v15 offset:2688
  s_waitcnt lgkmcnt(0)
  s_add_u32 m0, s68, 0
  s_mov_b32 s56, 2097152
  buffer_load_dwordx4 v8, s[12:15], s56 offen lds
  s_add_u32 m0, s68, 1024
  s_mov_b32 s56, 2228224
  buffer_load_dwordx4 v8, s[12:15], s56 offen lds
  s_add_u32 m0, s68, 2048
  s_mov_b32 s56, 917504
  buffer_load_dwordx4 v14, s[28:31], s56 offen lds
  s_add_u32 m0, s68, 3072
  s_mov_b32 s56, 917504
  buffer_load_dwordx4 v14, s[32:35], s56 offen lds
  s_waitcnt vmcnt(28)
  ds_read_b64_tr_b16 a[8:9], v9 offset:4096
  ds_read_b64_tr_b16 a[10:11], v9 offset:4352
  ds_read_b64_tr_b16 a[12:13], v9 offset:5120
  ds_read_b64_tr_b16 a[14:15], v9 offset:5376
  ds_read_b64_tr_b16 a[136:137], v15 offset:6144
  ds_read_b64_tr_b16 a[138:139], v15 offset:6272
  ds_read_b64_tr_b16 a[140:141], v15 offset:6656
  ds_read_b64_tr_b16 a[142:143], v15 offset:6784
  s_waitcnt lgkmcnt(0)
  s_add_u32 m0, s68, 4096
  s_mov_b32 s56, 2359296
  buffer_load_dwordx4 v8, s[12:15], s56 offen lds
  s_add_u32 m0, s68, 5120
  s_mov_b32 s56, 2490368
  buffer_load_dwordx4 v8, s[12:15], s56 offen lds
  s_add_u32 m0, s68, 6144
  s_mov_b32 s56, 1032192
  buffer_load_dwordx4 v14, s[28:31], s56 offen lds
  s_add_u32 m0, s68, 7168
  s_mov_b32 s56, 1032192
  buffer_load_dwordx4 v14, s[32:35], s56 offen lds
  s_waitcnt vmcnt(28)
  ds_read_b64_tr_b16 a[16:17], v9 offset:8192
  ds_read_b64_tr_b16 a[18:19], v9 offset:8448
  ds_read_b64_tr_b16 a[20:21], v9 offset:9216
  ds_read_b64_tr_b16 a[22:23], v9 offset:9472
  ds_read_b64_tr_b16 a[144:145], v15 offset:10240
  ds_read_b64_tr_b16 a[146:147], v15 offset:10368
  ds_read_b64_tr_b16 a[148:149], v15 offset:10752
  ds_read_b64_tr_b16 a[150:151], v15 offset:10880
  s_waitcnt lgkmcnt(0)
  s_add_u32 m0, s68, 8192
  s_mov_b32 s56, 2621440
  buffer_load_dwordx4 v8, s[12:15], s56 offen lds
  s_add_u32 m0, s68, 9216
  s_mov_b32 s56, 2752512
  buffer_load_dwordx4 v8, s[12:15], s56 offen lds
  s_add_u32 m0, s68, 10240
  s_mov_b32 s56, 1146880
  buffer_load_dwordx4 v14, s[28:31], s56 offen lds
  s_add_u32 m0, s68, 11264
  s_mov_b32 s56, 1146880
  buffer_load_dwordx4 v14, s[32:35], s56 offen lds
  s_waitcnt vmcnt(28)
  ds_read_b64_tr_b16 a[24:25], v9 offset:12288
  ds_read_b64_tr_b16 a[26:27], v9 offset:12544
  ds_read_b64_tr_b16 a[28:29], v9 offset:13312
  ds_read_b64_tr_b16 a[30:31], v9 offset:13568
  ds_read_b64_tr_b16 a[152:153], v15 offset:14336
  ds_read_b64_tr_b16 a[154:155], v15 offset:14464
  ds_read_b64_tr_b16 a[156:157], v15 offset:14848
  ds_read_b64_tr_b16 a[158:159], v15 offset:14976
  s_waitcnt lgkmcnt(0)
  s_add_u32 m0, s68, 12288
  s_mov_b32 s56, 2883584
  buffer_load_dwordx4 v8, s[12:15], s56 offen lds
  s_add_u32 m0, s68, 13312
  s_mov_b32 s56, 3014656
  buffer_load_dwordx4 v8, s[12:15], s56 offen lds
  s_add_u32 m0, s68, 14336
  s_mov_b32 s56, 1261568
  buffer_load_dwordx4 v14, s[28:31], s56 offen lds
  s_add_u32 m0, s68, 15360
  s_mov_b32 s56, 1261568
  buffer_load_dwordx4 v14, s[32:35], s56 offen lds
  s_waitcnt vmcnt(28)
  ds_read_b64_tr_b16 a[32:33], v9 offset:16384
  ds_read_b64_tr_b16 a[34:35], v9 offset:16640
  ds_read_b64_tr_b16 a[36:37], v9 offset:17408
  ds_read_b64_tr_b16 a[38:39], v9 offset:17664
  ds_read_b64_tr_b16 a[160:161], v15 offset:18432
  ds_read_b64_tr_b16 a[162:163], v15 offset:18560
  ds_read_b64_tr_b16 a[164:165], v15 offset:18944
  ds_read_b64_tr_b16 a[166:167], v15 offset:19072
  s_waitcnt lgkmcnt(0)
  s_add_u32 m0, s68, 16384
  s_mov_b32 s56, 3145728
  buffer_load_dwordx4 v8, s[12:15], s56 offen lds
  s_add_u32 m0, s68, 17408
  s_mov_b32 s56, 3276800
  buffer_load_dwordx4 v8, s[12:15], s56 offen lds
  s_add_u32 m0, s68, 18432
  s_mov_b32 s56, 1376256
  buffer_load_dwordx4 v14, s[28:31], s56 offen lds
  s_add_u32 m0, s68, 19456
  s_mov_b32 s56, 1376256
  buffer_load_dwordx4 v14, s[32:35], s56 offen lds
  s_waitcnt vmcnt(28)
  ds_read_b64_tr_b16 a[40:41], v9 offset:20480
  ds_read_b64_tr_b16 a[42:43], v9 offset:20736
  ds_read_b64_tr_b16 a[44:45], v9 offset:21504
  ds_read_b64_tr_b16 a[46:47], v9 offset:21760
  ds_read_b64_tr_b16 a[168:169], v15 offset:22528
  ds_read_b64_tr_b16 a[170:171], v15 offset:22656
  ds_read_b64_tr_b16 a[172:173], v15 offset:23040
  ds_read_b64_tr_b16 a[174:175], v15 offset:23168
  s_waitcnt lgkmcnt(0)
  s_add_u32 m0, s68, 20480
  s_mov_b32 s56, 3407872
  buffer_load_dwordx4 v8, s[12:15], s56 offen lds
  s_add_u32 m0, s68, 21504
  s_mov_b32 s56, 3538944
  buffer_load_dwordx4 v8, s[12:15], s56 offen lds
  s_add_u32 m0, s68, 22528
  s_mov_b32 s56, 1490944
  buffer_load_dwordx4 v14, s[28:31], s56 offen lds
  s_add_u32 m0, s68, 23552
  s_mov_b32 s56, 1490944
  buffer_load_dwordx4 v14, s[32:35], s56 offen lds
  s_waitcnt vmcnt(28)
  ds_read_b64_tr_b16 a[48:49], v9 offset:24576
  ds_read_b64_tr_b16 a[50:51], v9 offset:24832
  ds_read_b64_tr_b16 a[52:53], v9 offset:25600
  ds_read_b64_tr_b16 a[54:55], v9 offset:25856
  ds_read_b64_tr_b16 a[176:177], v15 offset:26624
  ds_read_b64_tr_b16 a[178:179], v15 offset:26752
  ds_read_b64_tr_b16 a[180:181], v15 offset:27136
  ds_read_b64_tr_b16 a[182:183], v15 offset:27264
  s_waitcnt lgkmcnt(0)
  s_add_u32 m0, s68, 24576
  s_mov_b32 s56, 3670016
  buffer_load_dwordx4 v8, s[12:15], s56 offen lds
  s_add_u32 m0, s68, 25600
  s_mov_b32 s56, 3801088
  buffer_load_dwordx4 v8, s[12:15], s56 offen lds
  s_add_u32 m0, s68, 26624
  s_mov_b32 s56, 1605632
  buffer_load_dwordx4 v14, s[28:31], s56 offen lds
  s_add_u32 m0, s68, 27648
  s_mov_b32 s56, 1605632
  buffer_load_dwordx4 v14, s[32:35], s56 offen lds
  s_waitcnt vmcnt(28)
  ds_read_b64_tr_b16 a[56:57], v9 offset:28672
  ds_read_b64_tr_b16 a[58:59], v9 offset:28928
  ds_read_b64_tr_b16 a[60:61], v9 offset:29696
  ds_read_b64_tr_b16 a[62:63], v9 offset:29952
  ds_read_b64_tr_b16 a[184:185], v15 offset:30720
  ds_read_b64_tr_b16 a[186:187], v15 offset:30848
  ds_read_b64_tr_b16 a[188:189], v15 offset:31232
  ds_read_b64_tr_b16 a[190:191], v15 offset:31360
  s_waitcnt lgkmcnt(0)
  s_add_u32 m0, s68, 28672
  s_mov_b32 s56, 3932160
  buffer_load_dwordx4 v8, s[12:15], s56 offen lds
  s_add_u32 m0, s68, 29696
  s_mov_b32 s56, 4063232
  buffer_load_dwordx4 v8, s[12:15], s56 offen lds
  s_add_u32 m0, s68, 30720
  s_mov_b32 s56, 1720320
  buffer_load_dwordx4 v14, s[28:31], s56 offen lds
  s_add_u32 m0, s68, 31744
  s_mov_b32 s56, 1720320
  buffer_load_dwordx4 v14, s[32:35], s56 offen lds
  s_waitcnt vmcnt(28)
  ds_read_b64_tr_b16 a[64:65], v9 offset:0
  ds_read_b64_tr_b16 a[66:67], v9 offset:256
  ds_read_b64_tr_b16 a[68:69], v9 offset:1024
  ds_read_b64_tr_b16 a[70:71], v9 offset:1280
  ds_read_b64_tr_b16 a[192:193], v15 offset:2048
  ds_read_b64_tr_b16 a[194:195], v15 offset:2176
  ds_read_b64_tr_b16 a[196:197], v15 offset:2560
  ds_read_b64_tr_b16 a[198:199], v15 offset:2688
  s_waitcnt vmcnt(24)
  ds_read_b64_tr_b16 a[72:73], v9 offset:4096
  ds_read_b64_tr_b16 a[74:75], v9 offset:4352
  ds_read_b64_tr_b16 a[76:77], v9 offset:5120
  ds_read_b64_tr_b16 a[78:79], v9 offset:5376
  ds_read_b64_tr_b16 a[200:201], v15 offset:6144
  ds_read_b64_tr_b16 a[202:203], v15 offset:6272
  ds_read_b64_tr_b16 a[204:205], v15 offset:6656
  ds_read_b64_tr_b16 a[206:207], v15 offset:6784
  s_waitcnt vmcnt(20)
  ds_read_b64_tr_b16 a[80:81], v9 offset:8192
  ds_read_b64_tr_b16 a[82:83], v9 offset:8448
  ds_read_b64_tr_b16 a[84:85], v9 offset:9216
  ds_read_b64_tr_b16 a[86:87], v9 offset:9472
  ds_read_b64_tr_b16 a[208:209], v15 offset:10240
  ds_read_b64_tr_b16 a[210:211], v15 offset:10368
  ds_read_b64_tr_b16 a[212:213], v15 offset:10752
  ds_read_b64_tr_b16 a[214:215], v15 offset:10880
  s_waitcnt vmcnt(16)
  ds_read_b64_tr_b16 a[88:89], v9 offset:12288
  ds_read_b64_tr_b16 a[90:91], v9 offset:12544
  ds_read_b64_tr_b16 a[92:93], v9 offset:13312
  ds_read_b64_tr_b16 a[94:95], v9 offset:13568
  ds_read_b64_tr_b16 a[216:217], v15 offset:14336
  ds_read_b64_tr_b16 a[218:219], v15 offset:14464
  ds_read_b64_tr_b16 a[220:221], v15 offset:14848
  ds_read_b64_tr_b16 a[222:223], v15 offset:14976
  s_waitcnt vmcnt(12)
  ds_read_b64_tr_b16 a[96:97], v9 offset:16384
  ds_read_b64_tr_b16 a[98:99], v9 offset:16640
  ds_read_b64_tr_b16 a[100:101], v9 offset:17408
  ds_read_b64_tr_b16 a[102:103], v9 offset:17664
  ds_read_b64_tr_b16 a[224:225], v15 offset:18432
  ds_read_b64_tr_b16 a[226:227], v15 offset:18560
  ds_read_b64_tr_b16 a[228:229], v15 offset:18944
  ds_read_b64_tr_b16 a[230:231], v15 offset:19072
  s_waitcnt vmcnt(8)
  ds_read_b64_tr_b16 a[104:105], v9 offset:20480
  ds_read_b64_tr_b16 a[106:107], v9 offset:20736
  ds_read_b64_tr_b16 a[108:109], v9 offset:21504
  ds_read_b64_tr_b16 a[110:111], v9 offset:21760
  ds_read_b64_tr_b16 a[232:233], v15 offset:22528
  ds_read_b64_tr_b16 a[234:235], v15 offset:22656
  ds_read_b64_tr_b16 a[236:237], v15 offset:23040
  ds_read_b64_tr_b16 a[238:239], v15 offset:23168
  s_waitcnt vmcnt(4)
  ds_read_b64_tr_b16 a[112:113], v9 offset:24576
  ds_read_b64_tr_b16 a[114:115], v9 offset:24832
  ds_read_b64_tr_b16 a[116:117], v9 offset:25600
  ds_read_b64_tr_b16 a[118:119], v9 offset:25856
  ds_read_b64_tr_b16 a[240:241], v15 offset:26624
  ds_read_b64_tr_b16 a[242:243], v15 offset:26752
  ds_read_b64_tr_b16 a[244:245], v15 offset:27136
  ds_read_b64_tr_b16 a[246:247], v15 offset:27264
  s_waitcnt vmcnt(0)
  ds_read_b64_tr_b16 a[120:121], v9 offset:28672
  ds_read_b64_tr_b16 a[122:123], v9 offset:28928
  ds_read_b64_tr_b16 a[124:125], v9 offset:29696
  ds_read_b64_tr_b16 a[126:127], v9 offset:29952
  ds_read_b64_tr_b16 a[248:249], v15 offset:30720
  ds_read_b64_tr_b16 a[250:251], v15 offset:30848
  ds_read_b64_tr_b16 a[252:253], v15 offset:31232
  ds_read_b64_tr_b16 a[254:255], v15 offset:31360
  s_waitcnt lgkmcnt(0)
  s_barrier
  s_mov_b32 s73, 3222493025
  s_mov_b32 s74, 3184710632
  s_mov_b32 s66, 1
  s_mov_b32 s67, s64
  s_mov_b32 s69, 0
  v_add_u32 v13, 131072, v2
  s_branch P2_PF
P2_LOOP:
  s_barrier
  s_sub_u32 s56, s66, 1
  s_max_i32 s56, s56, 1
  v_add_u32 v13, s69, v2
  s_xor_b32 s69, s69, 0x8000
  s_add_u32 s66, s66, 1
  s_cmp_eq_u32 s66, s65
  s_cbranch_scc1 P2_NOPF
P2_PF:
  s_add_u32 s59, s67, 7
  s_lshl_b32 s56, s59, 15
  s_lshl_b32 s57, s52, 13
  s_add_u32 s56, s56, s57
  s_add_u32 m0, s69, s57
  s_add_u32 s58, s56, 4096
  buffer_load_dwordx4 v2, s[48:51], s56 offen offset:0 sc1 lds
  buffer_load_dwordx4 v2, s[48:51], s56 offen offset:1024 sc1 lds
  buffer_load_dwordx4 v2, s[48:51], s56 offen offset:2048 sc1 lds
  buffer_load_dwordx4 v2, s[48:51], s56 offen offset:3072 sc1 lds
  s_add_u32 m0, m0, 4096
  s_nop 0
  buffer_load_dwordx4 v2, s[48:51], s58 offen offset:0 sc1 lds
  buffer_load_dwordx4 v2, s[48:51], s58 offen offset:1024 sc1 lds
  buffer_load_dwordx4 v2, s[48:51], s58 offen offset:2048 sc1 lds
  buffer_load_dwordx4 v2, s[48:51], s58 offen offset:3072 sc1 lds
  s_lshl_b32 s56, s85, 2
  s_add_u32 s56, s56, s52
  s_lshl3_add_u32 s56, s56, s66
  s_sub_u32 s56, s56, 1
  s_lshl_b32 s57, s56, 8
  s_mul_i32 s56, s56, 640
  v_lshlrev_b32 v4, 7, v1
  s_mov_b64 exec, 31
  buffer_load_dword v120, v4, s[24:27], s56 offen
  s_mov_b64 exec, -1
P2_NOPF:
  ds_read_b128 v[16:19], v13 offset:0
  ds_read_b128 v[20:23], v13 offset:1024
  ds_read_b128 v[24:27], v13 offset:2048
  ds_read_b128 v[28:31], v13 offset:3072
  ds_read_b128 v[32:35], v13 offset:4096
  ds_read_b128 v[36:39], v13 offset:5120
  ds_read_b128 v[40:43], v13 offset:6144
  ds_read_b128 v[44:47], v13 offset:7168
  s_waitcnt lgkmcnt(7)
  v_mfma_f32_32x32x16_bf16 v[64:79], a[128:131], v[16:19], 0
  v_mfma_f32_32x32x16_bf16 v[48:63], a[0:3], v[16:19], 0
  ds_read_b128 v[16:19], v13 offset:8192
  s_waitcnt lgkmcnt(7)
  v_mfma_f32_32x32x16_bf16 v[64:79], a[132:135], v[20:23], v[64:79]
  v_mfma_f32_32x32x16_bf16 v[48:63], a[4:7], v[20:23], v[48:63]
  ds_read_b128 v[20:23], v13 offset:9216
  s_waitcnt lgkmcnt(7)
  v_mfma_f32_32x32x16_bf16 v[64:79], a[136:139], v[24:27], v[64:79]
  v_mfma_f32_32x32x16_bf16 v[48:63], a[8:11], v[24:27], v[48:63]
  ds_read_b128 v[24:27], v13 offset:10240
  s_waitcnt lgkmcnt(7)
  v_mfma_f32_32x32x16_bf16 v[64:79], a[140:143], v[28:31], v[64:79]
  v_mfma_f32_32x32x16_bf16 v[48:63], a[12:15], v[28:31], v[48:63]
  ds_read_b128 v[28:31], v13 offset:11264
  s_waitcnt lgkmcnt(7)
  v_mfma_f32_32x32x16_bf16 v[64:79], a[144:147], v[32:35], v[64:79]
  v_mfma_f32_32x32x16_bf16 v[48:63], a[16:19], v[32:35], v[48:63]
  ds_read_b128 v[32:35], v13 offset:12288
  s_waitcnt lgkmcnt(7)
  v_mfma_f32_32x32x16_bf16 v[64:79], a[148:151], v[36:39], v[64:79]
  v_mfma_f32_32x32x16_bf16 v[48:63], a[20:23], v[36:39], v[48:63]
  ds_read_b128 v[36:39], v13 offset:13312
  s_waitcnt lgkmcnt(7)
  v_mfma_f32_32x32x16_bf16 v[64:79], a[152:155], v[40:43], v[64:79]
  v_mfma_f32_32x32x16_bf16 v[48:63], a[24:27], v[40:43], v[48:63]
  ds_read_b128 v[40:43], v13 offset:14336
  s_waitcnt lgkmcnt(7)
  v_mfma_f32_32x32x16_bf16 v[64:79], a[156:159], v[44:47], v[64:79]
  v_mfma_f32_32x32x16_bf16 v[48:63], a[28:31], v[44:47], v[48:63]
  ds_read_b128 v[44:47], v13 offset:15360
  s_waitcnt lgkmcnt(7)
  v_mfma_f32_32x32x16_bf16 v[64:79], a[160:163], v[16:19], v[64:79]
  v_mfma_f32_32x32x16_bf16 v[48:63], a[32:35], v[16:19], v[48:63]
  ds_read_b128 v[16:19], v13 offset:16384
  s_waitcnt lgkmcnt(7)
  v_mfma_f32_32x32x16_bf16 v[64:79], a[164:167], v[20:23], v[64:79]
  v_mfma_f32_32x32x16_bf16 v[48:63], a[36:39], v[20:23], v[48:63]
  ds_read_b128 v[20:23], v13 offset:17408
  s_waitcnt lgkmcnt(7)
  v_mfma_f32_32x32x16_bf16 v[64:79], a[168:171], v[24:27], v[64:79]
  v_mfma_f32_32x32x16_bf16 v[48:63], a[40:43], v[24:27], v[48:63]
  ds_read_b128 v[24:27], v13 offset:18432
  s_waitcnt lgkmcnt(7)
  v_mfma_f32_32x32x16_bf16 v[64:79], a[172:175], v[28:31], v[64:79]
  v_mfma_f32_32x32x16_bf16 v[48:63], a[44:47], v[28:31], v[48:63]
  ds_read_b128 v[28:31], v13 offset:19456
  s_waitcnt lgkmcnt(7)
  v_mfma_f32_32x32x16_bf16 v[64:79], a[176:179], v[32:35], v[64:79]
  v_mfma_f32_32x32x16_bf16 v[48:63], a[48:51], v[32:35], v[48:63]
  ds_read_b128 v[32:35], v13 offset:20480
  s_waitcnt lgkmcnt(7)
  v_mfma_f32_32x32x16_bf16 v[64:79], a[180:183], v[36:39], v[64:79]
  v_mfma_f32_32x32x16_bf16 v[48:63], a[52:55], v[36:39], v[48:63]
  ds_read_b128 v[36:39], v13 offset:21504
  s_waitcnt lgkmcnt(7)
  v_mfma_f32_32x32x16_bf16 v[64:79], a[184:187], v[40:43], v[64:79]
  v_mfma_f32_32x32x16_bf16 v[48:63], a[56:59], v[40:43], v[48:63]
  ds_read_b128 v[40:43], v13 offset:22528
  s_waitcnt lgkmcnt(7)
  v_mfma_f32_32x32x16_bf16 v[64:79], a[188:191], v[44:47], v[64:79]
  v_mfma_f32_32x32x16_bf16 v[48:63], a[60:63], v[44:47], v[48:63]
  ds_read_b128 v[44:47], v13 offset:23552
  s_waitcnt lgkmcnt(7)
  v_mfma_f32_32x32x16_bf16 v[64:79], a[192:195], v[16:19], v[64:79]
  v_mfma_f32_32x32x16_bf16 v[48:63], a[64:67], v[16:19], v[48:63]
  ds_read_b128 v[16:19], v13 offset:24576
  s_waitcnt lgkmcnt(7)
  v_mfma_f32_32x32x16_bf16 v[64:79], a[196:199], v[20:23], v[64:79]
  v_mfma_f32_32x32x16_bf16 v[48:63], a[68:71], v[20:23], v[48:63]
  ds_read_b128 v[20:23], v13 offset:25600
  s_waitcnt lgkmcnt(7)
  v_mfma_f32_32x32x16_bf16 v[64:79], a[200:203], v[24:27], v[64:79]
  v_mfma_f32_32x32x16_bf16 v[48:63], a[72:75], v[24:27], v[48:63]
  ds_read_b128 v[24:27], v13 offset:26624
  s_waitcnt lgkmcnt(7)
  v_mfma_f32_32x32x16_bf16 v[64:79], a[204:207], v[28:31], v[64:79]
  v_mfma_f32_32x32x16_bf16 v[48:63], a[76:79], v[28:31], v[48:63]
  ds_read_b128 v[28:31], v13 offset:27648
  s_waitcnt lgkmcnt(7)
  v_mfma_f32_32x32x16_bf16 v[64:79], a[208:211], v[32:35], v[64:79]
  v_mfma_f32_32x32x16_bf16 v[48:63], a[80:83], v[32:35], v[48:63]
  ds_read_b128 v[32:35], v13 offset:28672
  s_waitcnt lgkmcnt(7)
  v_mfma_f32_32x32x16_bf16 v[64:79], a[212:215], v[36:39], v[64:79]
  v_mfma_f32_32x32x16_bf16 v[48:63], a[84:87], v[36:39], v[48:63]
  ds_read_b128 v[36:39], v13 offset:29696
  s_waitcnt lgkmcnt(7)
  v_mfma_f32_32x32x16_bf16 v[64:79], a[216:219], v[40:43], v[64:79]
  v_mfma_f32_32x32x16_bf16 v[48:63], a[88:91], v[40:43], v[48:63]
  ds_read_b128 v[40:43], v13 offset:30720
  s_waitcnt lgkmcnt(7)
  v_mfma_f32_32x32x16_bf16 v[64:79], a[220:223], v[44:47], v[64:79]
  v_mfma_f32_32x32x16_bf16 v[48:63], a[92:95], v[44:47], v[48:63]
  ds_read_b128 v[44:47], v13 offset:31744
  s_waitcnt lgkmcnt(7)
  v_mfma_f32_32x32x16_bf16 v[64:79], a[224:227], v[16:19], v[64:79]
  v_mfma_f32_32x32x16_bf16 v[48:63], a[96:99], v[16:19], v[48:63]
  s_waitcnt lgkmcnt(6)
  v_mfma_f32_32x32x16_bf16 v[64:79], a[228:231], v[20:23], v[64:79]
  v_mfma_f32_32x32x16_bf16 v[48:63], a[100:103], v[20:23], v[48:63]
  s_waitcnt lgkmcnt(5)
  v_mfma_f32_32x32x16_bf16 v[64:79], a[232:235], v[24:27], v[64:79]
  v_mfma_f32_32x32x16_bf16 v[48:63], a[104:107], v[24:27], v[48:63]
  s_waitcnt lgkmcnt(4)
  v_mfma_f32_32x32x16_bf16 v[64:79], a[236:239], v[28:31], v[64:79]
  v_mfma_f32_32x32x16_bf16 v[48:63], a[108:111], v[28:31], v[48:63]
  s_waitcnt lgkmcnt(3)
  v_mfma_f32_32x32x16_bf16 v[64:79], a[240:243], v[32:35], v[64:79]
  v_mfma_f32_32x32x16_bf16 v[48:63], a[112:115], v[32:35], v[48:63]
  s_waitcnt lgkmcnt(2)
  v_mfma_f32_32x32x16_bf16 v[64:79], a[244:247], v[36:39], v[64:79]
  v_mfma_f32_32x32x16_bf16 v[48:63], a[116:119], v[36:39], v[48:63]
  s_waitcnt lgkmcnt(1)
  v_mfma_f32_32x32x16_bf16 v[64:79], a[248:251], v[40:43], v[64:79]
  v_mfma_f32_32x32x16_bf16 v[48:63], a[120:123], v[40:43], v[48:63]
  s_waitcnt lgkmcnt(0)
  v_mfma_f32_32x32x16_bf16 v[64:79], a[252:255], v[44:47], v[64:79]
  v_mfma_f32_32x32x16_bf16 v[48:63], a[124:127], v[44:47], v[48:63]
  s_lshl_b32 s56, s67, 18
  s_lshl_b32 s57, s67, 17
  s_add_u32 s56, s56, s75
  s_add_u32 s57, s57, 61865984
  s_add_u32 s56, s56, 35651584
  v_mov_b32 v4, s73
  s_nop 4
  v_mul_f32 v88, v64, v64
  v_mul_f32 v89, v65, v65
  v_mul_f32 v90, v66, v66
  v_mul_f32 v91, v67, v67
  v_mul_f32 v92, v68, v68
  v_mul_f32 v93, v69, v69
  v_mul_f32 v94, v70, v70
  v_mul_f32 v95, v71, v71
  v_fma_f32 v88, v88, s74, v4
  v_fma_f32 v89, v89, s74, v4
  v_fma_f32 v90, v90, s74, v4
  v_fma_f32 v91, v91, s74, v4
  v_fma_f32 v92, v92, s74, v4
  v_fma_f32 v93, v93, s74, v4
  v_fma_f32 v94, v94, s74, v4
  v_fma_f32 v95, v95, s74, v4
  v_mul_f32 v88, v88, v64
  v_mul_f32 v89, v89, v65
  v_mul_f32 v90, v90, v66
  v_mul_f32 v91, v91, v67
  v_mul_f32 v92, v92, v68
  v_mul_f32 v93, v93, v69
  v_mul_f32 v94, v94, v70
  v_mul_f32 v95, v95, v71
  v_cvt_pk_bf16_f32 v80, v48, v49
  v_cvt_pk_bf16_f32 v81, v50, v51
  v_cvt_pk_bf16_f32 v82, v52, v53
  v_cvt_pk_bf16_f32 v83, v54, v55
  v_cvt_pk_bf16_f32 v84, v56, v57
  v_cvt_pk_bf16_f32 v85, v58, v59
  v_cvt_pk_bf16_f32 v86, v60, v61
  v_cvt_pk_bf16_f32 v87, v62, v63
  buffer_store_dwordx4 v[80:83], v11, s[48:51], s56 offen sc1
  buffer_store_dwordx4 v[84:87], v11, s[48:51], s56 offen offset:512 sc1
  v_exp_f32 v88, v88
  v_exp_f32 v89, v89
  v_exp_f32 v90, v90
  v_exp_f32 v91, v91
  v_exp_f32 v92, v92
  v_exp_f32 v93, v93
  v_exp_f32 v94, v94
  v_exp_f32 v95, v95
  v_add_f32 v88, 1.0, v88
  v_add_f32 v89, 1.0, v89
  v_add_f32 v90, 1.0, v90
  v_add_f32 v91, 1.0, v91
  v_add_f32 v92, 1.0, v92
  v_add_f32 v93, 1.0, v93
  v_add_f32 v94, 1.0, v94
  v_add_f32 v95, 1.0, v95
  v_rcp_f32 v88, v88
  v_rcp_f32 v89, v89
  v_rcp_f32 v90, v90
  v_rcp_f32 v91, v91
  v_rcp_f32 v92, v92
  v_rcp_f32 v93, v93
  v_rcp_f32 v94, v94
  v_rcp_f32 v95, v95
  v_mul_f32 v88, v88, v64
  v_mul_f32 v89, v89, v65
  v_mul_f32 v90, v90, v66
  v_mul_f32 v91, v91, v67
  v_mul_f32 v92, v92, v68
  v_mul_f32 v93, v93, v69
  v_mul_f32 v94, v94, v70
  v_mul_f32 v95, v95, v71
  v_mul_f32 v88, v88, v72
  v_mul_f32 v89, v89, v73
  v_mul_f32 v90, v90, v74
  v_mul_f32 v91, v91, v75
  v_mul_f32 v92, v92, v76
  v_mul_f32 v93, v93, v77
  v_mul_f32 v94, v94, v78
  v_mul_f32 v95, v95, v79
  v_cvt_pk_bf16_f32 v96, v88, v89
  v_cvt_pk_bf16_f32 v97, v90, v91
  v_cvt_pk_bf16_f32 v98, v92, v93
  v_cvt_pk_bf16_f32 v99, v94, v95
  buffer_store_dwordx4 v[96:99], v10, s[48:51], s57 offen sc1
  s_add_u32 s67, s67, 7
  s_cmp_eq_u32 s66, s65
  s_waitcnt vmcnt(3)
  s_cbranch_scc0 P2_LOOP
  s_waitcnt vmcnt(0)
  s_barrier
  s_cmp_eq_u32 s52, 0
  s_cbranch_scc0 NOPUB_H
  v_mov_b32 v4, 1
  s_mov_b64 exec, 1
  buffer_store_dword v4, off, s[48:51], s72 sc1
  s_mov_b64 exec, -1
NOPUB_H:
  s_mov_b32 s54, s83
  s_mov_b32 s53, s84
  s_sub_u32 s64, s54, 1
  s_cmp_eq_u32 s64, 0
  s_cselect_b32 s65, 10, 9
  s_lshl_b32 s70, s53, 13
  s_lshl_b32 s56, s54, 12
  s_lshl_b32 s57, s53, 7
  s_add_u32 s72, s56, s57
  s_add_u32 s72, s72, 89137152
  v_lshrrev_b32 v4, 2, v1
  v_and_b32 v5, 3, v1
  v_lshlrev_b32 v8, 10, v4
  v_lshl_add_u32 v8, v5, 4, v8
  s_lshr_b32 s56, s53, 1
  s_lshl_b32 s56, s56, 6
  s_lshl_b32 s57, s52, 20
  s_add_u32 s57, s57, s56
  v_add_u32 v9, s57, v8
  s_mul_i32 s57, s52, 458752
  s_add_u32 s57, s57, s56
  v_add_u32 v8, s57, v8
  v_lshlrev_b32 v10, 4, v5
  v_and_b32 v4, 3, v4
  v_lshl_add_u32 v10, v4, 6, v10
  v_lshrrev_b32 v4, 4, v1
  v_lshl_add_u32 v10, v4, 9, v10
  v_add_u32 v10, s68, v10
  s_add_u32 m0, s68, 0
  s_mov_b32 s56, 0
  buffer_load_dwordx4 v8, s[36:39], s56 offen lds
  s_add_u32 m0, s68, 1024
  s_mov_b32 s56, 16384
  buffer_load_dwordx4 v8, s[36:39], s56 offen lds
  s_add_u32 m0, s68, 2048
  s_mov_b32 s56, 32768
  buffer_load_dwordx4 v8, s[36:39], s56 offen lds
  s_add_u32 m0, s68, 3072
  s_mov_b32 s56, 49152
  buffer_load_dwordx4 v8, s[36:39], s56 offen lds
  s_add_u32 m0, s68, 4096
  s_mov_b32 s56, 65536
  buffer_load_dwordx4 v8, s[36:39], s56 offen lds
  s_add_u32 m0, s68, 5120
  s_mov_b32 s56, 81920
  buffer_load_dwordx4 v8, s[36:39], s56 offen lds
  s_add_u32 m0, s68, 6144
  s_mov_b32 s56, 98304
  buffer_load_dwordx4 v8, s[36:39], s56 offen lds
  s_add_u32 m0, s68, 7168
  s_mov_b32 s56, 114688
  buffer_load_dwordx4 v8, s[36:39], s56 offen lds
  s_add_u32 m0, s68, 8192
  s_mov_b32 s56, 131072
  buffer_load_dwordx4 v8, s[36:39], s56 offen lds
  s_add_u32 m0, s68, 9216
  s_mov_b32 s56, 147456
  buffer_load_dwordx4 v8, s[36:39], s56 offen lds
  s_add_u32 m0, s68, 10240
  s_mov_b32 s56, 163840
  buffer_load_dwordx4 v8, s[36:39], s56 offen lds
  s_add_u32 m0, s68, 11264
  s_mov_b32 s56, 180224
  buffer_load_dwordx4 v8, s[36:39], s56 offen lds
  s_add_u32 m0, s68, 12288
  s_mov_b32 s56, 196608
  buffer_load_dwordx4 v8, s[36:39], s56 offen lds
  s_add_u32 m0, s68, 13312
  s_mov_b32 s56, 212992
  buffer_load_dwordx4 v8, s[36:39], s56 offen lds
  s_add_u32 m0, s68, 14336
  s_mov_b32 s56, 229376
  buffer_load_dwordx4 v8, s[36:39], s56 offen lds
  s_add_u32 m0, s68, 15360
  s_mov_b32 s56, 245760
  buffer_load_dwordx4 v8, s[36:39], s56 offen lds
  s_add_u32 m0, s68, 16384
  s_mov_b32 s56, 262144
  buffer_load_dwordx4 v8, s[36:39], s56 offen lds
  s_add_u32 m0, s68, 17408
  s_mov_b32 s56, 278528
  buffer_load_dwordx4 v8, s[36:39], s56 offen lds
  s_add_u32 m0, s68, 18432
  s_mov_b32 s56, 294912
  buffer_load_dwordx4 v8, s[36:39], s56 offen lds
  s_add_u32 m0, s68, 19456
  s_mov_b32 s56, 311296
  buffer_load_dwordx4 v8, s[36:39], s56 offen lds
  s_add_u32 m0, s68, 20480
  s_mov_b32 s56, 327680
  buffer_load_dwordx4 v8, s[36:39], s56 offen lds
  s_add_u32 m0, s68, 21504
  s_mov_b32 s56, 344064
  buffer_load_dwordx4 v8, s[36:39], s56 offen lds
  s_add_u32 m0, s68, 22528
  s_mov_b32 s56, 360448
  buffer_load_dwordx4 v8, s[36:39], s56 offen lds
  s_add_u32 m0, s68, 23552
  s_mov_b32 s56, 376832
  buffer_load_dwordx4 v8, s[36:39], s56 offen lds
  s_add_u32 m0, s68, 24576
  s_mov_b32 s56, 393216
  buffer_load_dwordx4 v8, s[36:39], s56 offen lds
  s_add_u32 m0, s68, 25600
  s_mov_b32 s56, 409600
  buffer_load_dwordx4 v8, s[36:39], s56 offen lds
  s_add_u32 m0, s68, 26624
  s_mov_b32 s56, 425984
  buffer_load_dwordx4 v8, s[36:39], s56 offen lds
  s_add_u32 m0, s68, 27648
  s_mov_b32 s56, 442368
  buffer_load_dwordx4 v8, s[36:39], s56 offen lds
  s_add_u32 m0, s68, 28672
  s_mov_b32 s56, 0
  buffer_load_dwordx4 v9, s[24:27], s56 offen lds
  s_add_u32 m0, s68, 29696
  s_mov_b32 s56, 16384
  buffer_load_dwordx4 v9, s[24:27], s56 offen lds
  s_add_u32 m0, s68, 30720
  s_mov_b32 s56, 32768
  buffer_load_dwordx4 v9, s[24:27], s56 offen lds
  s_add_u32 m0, s68, 31744
  s_mov_b32 s56, 49152
  buffer_load_dwordx4 v9, s[24:27], s56 offen lds
  s_waitcnt vmcnt(28)
  ds_read_b64_tr_b16 v[128:129], v10 offset:0
  ds_read_b64_tr_b16 v[130:131], v10 offset:256
  ds_read_b64_tr_b16 v[132:133], v10 offset:8
  ds_read_b64_tr_b16 v[134:135], v10 offset:264
  ds_read_b64_tr_b16 v[136:137], v10 offset:2048
  ds_read_b64_tr_b16 v[138:139], v10 offset:2304
  ds_read_b64_tr_b16 v[140:141], v10 offset:2056
  ds_read_b64_tr_b16 v[142:143], v10 offset:2312
  s_waitcnt lgkmcnt(0)
  s_add_u32 m0, s68, 0
  s_mov_b32 s56, 65536
  buffer_load_dwordx4 v9, s[24:27], s56 offen lds
  s_add_u32 m0, s68, 1024
  s_mov_b32 s56, 81920
  buffer_load_dwordx4 v9, s[24:27], s56 offen lds
  s_add_u32 m0, s68, 2048
  s_mov_b32 s56, 98304
  buffer_load_dwordx4 v9, s[24:27], s56 offen lds
  s_add_u32 m0, s68, 3072
  s_mov_b32 s56, 114688
  buffer_load_dwordx4 v9, s[24:27], s56 offen lds
  s_waitcnt vmcnt(28)
  ds_read_b64_tr_b16 v[144:145], v10 offset:4096
  ds_read_b64_tr_b16 v[146:147], v10 offset:4352
  ds_read_b64_tr_b16 v[148:149], v10 offset:4104
  ds_read_b64_tr_b16 v[150:151], v10 offset:4360
  ds_read_b64_tr_b16 v[152:153], v10 offset:6144
  ds_read_b64_tr_b16 v[154:155], v10 offset:6400
  ds_read_b64_tr_b16 v[156:157], v10 offset:6152
  ds_read_b64_tr_b16 v[158:159], v10 offset:6408
  s_waitcnt lgkmcnt(0)
  s_add_u32 m0, s68, 4096
  s_mov_b32 s56, 131072
  buffer_load_dwordx4 v9, s[24:27], s56 offen lds
  s_add_u32 m0, s68, 5120
  s_mov_b32 s56, 147456
  buffer_load_dwordx4 v9, s[24:27], s56 offen lds
  s_add_u32 m0, s68, 6144
  s_mov_b32 s56, 163840
  buffer_load_dwordx4 v9, s[24:27], s56 offen lds
  s_add_u32 m0, s68, 7168
  s_mov_b32 s56, 180224
  buffer_load_dwordx4 v9, s[24:27], s56 offen lds
  s_waitcnt vmcnt(28)
  ds_read_b64_tr_b16 v[160:161], v10 offset:8192
  ds_read_b64_tr_b16 v[162:163], v10 offset:8448
  ds_read_b64_tr_b16 v[164:165], v10 offset:8200
  ds_read_b64_tr_b16 v[166:167], v10 offset:8456
  ds_read_b64_tr_b16 v[168:169], v10 offset:10240
  ds_read_b64_tr_b16 v[170:171], v10 offset:10496
  ds_read_b64_tr_b16 v[172:173], v10 offset:10248
  ds_read_b64_tr_b16 v[174:175], v10 offset:10504
  s_waitcnt lgkmcnt(0)
  s_add_u32 m0, s68, 8192
  s_mov_b32 s56, 196608
  buffer_load_dwordx4 v9, s[24:27], s56 offen lds
  s_add_u32 m0, s68, 9216
  s_mov_b32 s56, 212992
  buffer_load_dwordx4 v9, s[24:27], s56 offen lds
  s_add_u32 m0, s68, 10240
  s_mov_b32 s56, 229376
  buffer_load_dwordx4 v9, s[24:27], s56 offen lds
  s_add_u32 m0, s68, 11264
  s_mov_b32 s56, 245760
  buffer_load_dwordx4 v9, s[24:27], s56 offen lds
  s_waitcnt vmcnt(28)
  ds_read_b64_tr_b16 v[176:177], v10 offset:12288
  ds_read_b64_tr_b16 v[178:179], v10 offset:12544
  ds_read_b64_tr_b16 v[180:181], v10 offset:12296
  ds_read_b64_tr_b16 v[182:183], v10 offset:12552
  ds_read_b64_tr_b16 v[184:185], v10 offset:14336
  ds_read_b64_tr_b16 v[186:187], v10 offset:14592
  ds_read_b64_tr_b16 v[188:189], v10 offset:14344
  ds_read_b64_tr_b16 v[190:191], v10 offset:14600
  s_waitcnt lgkmcnt(0)
  s_add_u32 m0, s68, 12288
  s_mov_b32 s56, 262144
  buffer_load_dwordx4 v9, s[24:27], s56 offen lds
  s_add_u32 m0, s68, 13312
  s_mov_b32 s56, 278528
  buffer_load_dwordx4 v9, s[24:27], s56 offen lds
  s_add_u32 m0, s68, 14336
  s_mov_b32 s56, 294912
  buffer_load_dwordx4 v9, s[24:27], s56 offen lds
  s_add_u32 m0, s68, 15360
  s_mov_b32 s56, 311296
  buffer_load_dwordx4 v9, s[24:27], s56 offen lds
  s_waitcnt vmcnt(28)
  ds_read_b64_tr_b16 v[192:193], v10 offset:16384
  ds_read_b64_tr_b16 v[194:195], v10 offset:16640
  ds_read_b64_tr_b16 v[196:197], v10 offset:16392
  ds_read_b64_tr_b16 v[198:199], v10 offset:16648
  ds_read_b64_tr_b16 v[200:201], v10 offset:18432
  ds_read_b64_tr_b16 v[202:203], v10 offset:18688
  ds_read_b64_tr_b16 v[204:205], v10 offset:18440
  ds_read_b64_tr_b16 v[206:207], v10 offset:18696
  s_waitcnt lgkmcnt(0)
  s_add_u32 m0, s68, 16384
  s_mov_b32 s56, 327680
  buffer_load_dwordx4 v9, s[24:27], s56 offen lds
  s_add_u32 m0, s68, 17408
  s_mov_b32 s56, 344064
  buffer_load_dwordx4 v9, s[24:27], s56 offen lds
  s_add_u32 m0, s68, 18432
  s_mov_b32 s56, 360448
  buffer_load_dwordx4 v9, s[24:27], s56 offen lds
  s_add_u32 m0, s68, 19456
  s_mov_b32 s56, 376832
  buffer_load_dwordx4 v9, s[24:27], s56 offen lds
  s_waitcnt vmcnt(28)
  ds_read_b64_tr_b16 v[208:209], v10 offset:20480
  ds_read_b64_tr_b16 v[210:211], v10 offset:20736
  ds_read_b64_tr_b16 v[212:213], v10 offset:20488
  ds_read_b64_tr_b16 v[214:215], v10 offset:20744
  ds_read_b64_tr_b16 v[216:217], v10 offset:22528
  ds_read_b64_tr_b16 v[218:219], v10 offset:22784
  ds_read_b64_tr_b16 v[220:221], v10 offset:22536
  ds_read_b64_tr_b16 v[222:223], v10 offset:22792
  s_waitcnt lgkmcnt(0)
  s_add_u32 m0, s68, 20480
  s_mov_b32 s56, 393216
  buffer_load_dwordx4 v9, s[24:27], s56 offen lds
  s_add_u32 m0, s68, 21504
  s_mov_b32 s56, 409600
  buffer_load_dwordx4 v9, s[24:27], s56 offen lds
  s_add_u32 m0, s68, 22528
  s_mov_b32 s56, 425984
  buffer_load_dwordx4 v9, s[24:27], s56 offen lds
  s_add_u32 m0, s68, 23552
  s_mov_b32 s56, 442368
  buffer_load_dwordx4 v9, s[24:27], s56 offen lds
  s_waitcnt vmcnt(28)
  ds_read_b64_tr_b16 v[224:225], v10 offset:24576
  ds_read_b64_tr_b16 v[226:227], v10 offset:24832
  ds_read_b64_tr_b16 v[228:229], v10 offset:24584
  ds_read_b64_tr_b16 v[230:231], v10 offset:24840
  ds_read_b64_tr_b16 v[232:233], v10 offset:26624
  ds_read_b64_tr_b16 v[234:235], v10 offset:26880
  ds_read_b64_tr_b16 v[236:237], v10 offset:26632
  ds_read_b64_tr_b16 v[238:239], v10 offset:26888
  s_waitcnt lgkmcnt(0)
  s_add_u32 m0, s68, 24576
  s_mov_b32 s56, 458752
  buffer_load_dwordx4 v9, s[24:27], s56 offen lds
  s_add_u32 m0, s68, 25600
  s_mov_b32 s56, 475136
  buffer_load_dwordx4 v9, s[24:27], s56 offen lds
  s_add_u32 m0, s68, 26624
  s_mov_b32 s56, 491520
  buffer_load_dwordx4 v9, s[24:27], s56 offen lds
  s_add_u32 m0, s68, 27648
  s_mov_b32 s56, 507904
  buffer_load_dwordx4 v9, s[24:27], s56 offen lds
  s_waitcnt vmcnt(28)
  ds_read_b64_tr_b16 a[0:1], v10 offset:28672
  ds_read_b64_tr_b16 a[2:3], v10 offset:28928
  ds_read_b64_tr_b16 a[4:5], v10 offset:28680
  ds_read_b64_tr_b16 a[6:7], v10 offset:28936
  ds_read_b64_tr_b16 a[8:9], v10 offset:30720
  ds_read_b64_tr_b16 a[10:11], v10 offset:30976
  ds_read_b64_tr_b16 a[12:13], v10 offset:30728
  ds_read_b64_tr_b16 a[14:15], v10 offset:30984
  s_waitcnt lgkmcnt(0)
  s_add_u32 m0, s68, 28672
  s_mov_b32 s56, 524288
  buffer_load_dwordx4 v9, s[24:27], s56 offen lds
  s_add_u32 m0, s68, 29696
  s_mov_b32 s56, 540672
  buffer_load_dwordx4 v9, s[24:27], s56 offen lds
  s_add_u32 m0, s68, 30720
  s_mov_b32 s56, 557056
  buffer_load_dwordx4 v9, s[24:27], s56 offen lds
  s_add_u32 m0, s68, 31744
  s_mov_b32 s56, 573440
  buffer_load_dwordx4 v9, s[24:27], s56 offen lds
  s_waitcnt vmcnt(28)
  ds_read_b64_tr_b16 a[16:17], v10 offset:0
  ds_read_b64_tr_b16 a[18:19], v10 offset:256
  ds_read_b64_tr_b16 a[20:21], v10 offset:8
  ds_read_b64_tr_b16 a[22:23], v10 offset:264
  ds_read_b64_tr_b16 a[24:25], v10 offset:2048
  ds_read_b64_tr_b16 a[26:27], v10 offset:2304
  ds_read_b64_tr_b16 a[28:29], v10 offset:2056
  ds_read_b64_tr_b16 a[30:31], v10 offset:2312
  s_waitcnt lgkmcnt(0)
  s_add_u32 m0, s68, 0
  s_mov_b32 s56, 589824
  buffer_load_dwordx4 v9, s[24:27], s56 offen lds
  s_add_u32 m0, s68, 1024
  s_mov_b32 s56, 606208
  buffer_load_dwordx4 v9, s[24:27], s56 offen lds
  s_add_u32 m0, s68, 2048
  s_mov_b32 s56, 622592
  buffer_load_dwordx4 v9, s[24:27], s56 offen lds
  s_add_u32 m0, s68, 3072
  s_mov_b32 s56, 638976
  buffer_load_dwordx4 v9, s[24:27], s56 offen lds
  s_waitcnt vmcnt(28)
  ds_read_b64_tr_b16 a[32:33], v10 offset:4096
  ds_read_b64_tr_b16 a[34:35], v10 offset:4352
  ds_read_b64_tr_b16 a[36:37], v10 offset:4104
  ds_read_b64_tr_b16 a[38:39], v10 offset:4360
  ds_read_b64_tr_b16 a[40:41], v10 offset:6144
  ds_read_b64_tr_b16 a[42:43], v10 offset:6400
  ds_read_b64_tr_b16 a[44:45], v10 offset:6152
  ds_read_b64_tr_b16 a[46:47], v10 offset:6408
  s_waitcnt lgkmcnt(0)
  s_add_u32 m0, s68, 4096
  s_mov_b32 s56, 655360
  buffer_load_dwordx4 v9, s[24:27], s56 offen lds
  s_add_u32 m0, s68, 5120
  s_mov_b32 s56, 671744
  buffer_load_dwordx4 v9, s[24:27], s56 offen lds
  s_add_u32 m0, s68, 6144
  s_mov_b32 s56, 688128
  buffer_load_dwordx4 v9, s[24:27], s56 offen lds
  s_add_u32 m0, s68, 7168
  s_mov_b32 s56, 704512
  buffer_load_dwordx4 v9, s[24:27], s56 offen lds
  s_waitcnt vmcnt(28)
  ds_read_b64_tr_b16 a[48:49], v10 offset:8192
  ds_read_b64_tr_b16 a[50:51], v10 offset:8448
  ds_read_b64_tr_b16 a[52:53], v10 offset:8200
  ds_read_b64_tr_b16 a[54:55], v10 offset:8456
  ds_read_b64_tr_b16 a[56:57], v10 offset:10240
  ds_read_b64_tr_b16 a[58:59], v10 offset:10496
  ds_read_b64_tr_b16 a[60:61], v10 offset:10248
  ds_read_b64_tr_b16 a[62:63], v10 offset:10504
  s_waitcnt lgkmcnt(0)
  s_add_u32 m0, s68, 8192
  s_mov_b32 s56, 720896
  buffer_load_dwordx4 v9, s[24:27], s56 offen lds
  s_add_u32 m0, s68, 9216
  s_mov_b32 s56, 737280
  buffer_load_dwordx4 v9, s[24:27], s56 offen lds
  s_add_u32 m0, s68, 10240
  s_mov_b32 s56, 753664
  buffer_load_dwordx4 v9, s[24:27], s56 offen lds
  s_add_u32 m0, s68, 11264
  s_mov_b32 s56, 770048
  buffer_load_dwordx4 v9, s[24:27], s56 offen lds
  s_waitcnt vmcnt(28)
  ds_read_b64_tr_b16 a[64:65], v10 offset:12288
  ds_read_b64_tr_b16 a[66:67], v10 offset:12544
  ds_read_b64_tr_b16 a[68:69], v10 offset:12296
  ds_read_b64_tr_b16 a[70:71], v10 offset:12552
  ds_read_b64_tr_b16 a[72:73], v10 offset:14336
  ds_read_b64_tr_b16 a[74:75], v10 offset:14592
  ds_read_b64_tr_b16 a[76:77], v10 offset:14344
  ds_read_b64_tr_b16 a[78:79], v10 offset:14600
  s_waitcnt lgkmcnt(0)
  s_add_u32 m0, s68, 12288
  s_mov_b32 s56, 786432
  buffer_load_dwordx4 v9, s[24:27], s56 offen lds
  s_add_u32 m0, s68, 13312
  s_mov_b32 s56, 802816
  buffer_load_dwordx4 v9, s[24:27], s56 offen lds
  s_add_u32 m0, s68, 14336
  s_mov_b32 s56, 819200
  buffer_load_dwordx4 v9, s[24:27], s56 offen lds
  s_add_u32 m0, s68, 15360
  s_mov_b32 s56, 835584
  buffer_load_dwordx4 v9, s[24:27], s56 offen lds
  s_waitcnt vmcnt(28)
  ds_read_b64_tr_b16 a[80:81], v10 offset:16384
  ds_read_b64_tr_b16 a[82:83], v10 offset:16640
  ds_read_b64_tr_b16 a[84:85], v10 offset:16392
  ds_read_b64_tr_b16 a[86:87], v10 offset:16648
  ds_read_b64_tr_b16 a[88:89], v10 offset:18432
  ds_read_b64_tr_b16 a[90:91], v10 offset:18688
  ds_read_b64_tr_b16 a[92:93], v10 offset:18440
  ds_read_b64_tr_b16 a[94:95], v10 offset:18696
  s_waitcnt lgkmcnt(0)
  s_add_u32 m0, s68, 16384
  s_mov_b32 s56, 851968
  buffer_load_dwordx4 v9, s[24:27], s56 offen lds
  s_add_u32 m0, s68, 17408
  s_mov_b32 s56, 868352
  buffer_load_dwordx4 v9, s[24:27], s56 offen lds
  s_add_u32 m0, s68, 18432
  s_mov_b32 s56, 884736
  buffer_load_dwordx4 v9, s[24:27], s56 offen lds
  s_add_u32 m0, s68, 19456
  s_mov_b32 s56, 901120
  buffer_load_dwordx4 v9, s[24:27], s56 offen lds
  s_waitcnt vmcnt(28)
  ds_read_b64_tr_b16 a[96:97], v10 offset:20480
  ds_read_b64_tr_b16 a[98:99], v10 offset:20736
  ds_read_b64_tr_b16 a[100:101], v10 offset:20488
  ds_read_b64_tr_b16 a[102:103], v10 offset:20744
  ds_read_b64_tr_b16 a[104:105], v10 offset:22528
  ds_read_b64_tr_b16 a[106:107], v10 offset:22784
  ds_read_b64_tr_b16 a[108:109], v10 offset:22536
  ds_read_b64_tr_b16 a[110:111], v10 offset:22792
  s_waitcnt lgkmcnt(0)
  s_add_u32 m0, s68, 20480
  s_mov_b32 s56, 917504
  buffer_load_dwordx4 v9, s[24:27], s56 offen lds
  s_add_u32 m0, s68, 21504
  s_mov_b32 s56, 933888
  buffer_load_dwordx4 v9, s[24:27], s56 offen lds
  s_add_u32 m0, s68, 22528
  s_mov_b32 s56, 950272
  buffer_load_dwordx4 v9, s[24:27], s56 offen lds
  s_add_u32 m0, s68, 23552
  s_mov_b32 s56, 966656
  buffer_load_dwordx4 v9, s[24:27], s56 offen lds
  s_waitcnt vmcnt(28)
  ds_read_b64_tr_b16 a[112:113], v10 offset:24576
  ds_read_b64_tr_b16 a[114:115], v10 offset:24832
  ds_read_b64_tr_b16 a[116:117], v10 offset:24584
  ds_read_b64_tr_b16 a[118:119], v10 offset:24840
  ds_read_b64_tr_b16 a[120:121], v10 offset:26624
  ds_read_b64_tr_b16 a[122:123], v10 offset:26880
  ds_read_b64_tr_b16 a[124:125], v10 offset:26632
  ds_read_b64_tr_b16 a[126:127], v10 offset:26888
  s_waitcnt lgkmcnt(0)
  s_add_u32 m0, s68, 24576
  s_mov_b32 s56, 983040
  buffer_load_dwordx4 v9, s[24:27], s56 offen lds
  s_add_u32 m0, s68, 25600
  s_mov_b32 s56, 999424
  buffer_load_dwordx4 v9, s[24:27], s56 offen lds
  s_add_u32 m0, s68, 26624
  s_mov_b32 s56, 1015808
  buffer_load_dwordx4 v9, s[24:27], s56 offen lds
  s_add_u32 m0, s68, 27648
  s_mov_b32 s56, 1032192
  buffer_load_dwordx4 v9, s[24:27], s56 offen lds
  s_waitcnt vmcnt(28)
  ds_read_b64_tr_b16 a[128:129], v10 offset:28672
  ds_read_b64_tr_b16 a[130:131], v10 offset:28928
  ds_read_b64_tr_b16 a[132:133], v10 offset:28680
  ds_read_b64_tr_b16 a[134:135], v10 offset:28936
  ds_read_b64_tr_b16 a[136:137], v10 offset:30720
  ds_read_b64_tr_b16 a[138:139], v10 offset:30976
  ds_read_b64_tr_b16 a[140:141], v10 offset:30728
  ds_read_b64_tr_b16 a[142:143], v10 offset:30984
  s_waitcnt vmcnt(24)
  ds_read_b64_tr_b16 a[144:145], v10 offset:0
  ds_read_b64_tr_b16 a[146:147], v10 offset:256
  ds_read_b64_tr_b16 a[148:149], v10 offset:8
  ds_read_b64_tr_b16 a[150:151], v10 offset:264
  ds_read_b64_tr_b16 a[152:153], v10 offset:2048
  ds_read_b64_tr_b16 a[154:155], v10 offset:2304
  ds_read_b64_tr_b16 a[156:157], v10 offset:2056
  ds_read_b64_tr_b16 a[158:159], v10 offset:2312
  s_waitcnt vmcnt(20)
  ds_read_b64_tr_b16 a[160:161], v10 offset:4096
  ds_read_b64_tr_b16 a[162:163], v10 offset:4352
  ds_read_b64_tr_b16 a[164:165], v10 offset:4104
  ds_read_b64_tr_b16 a[166:167], v10 offset:4360
  ds_read_b64_tr_b16 a[168:169], v10 offset:6144
  ds_read_b64_tr_b16 a[170:171], v10 offset:6400
  ds_read_b64_tr_b16 a[172:173], v10 offset:6152
  ds_read_b64_tr_b16 a[174:175], v10 offset:6408
  s_waitcnt vmcnt(16)
  ds_read_b64_tr_b16 a[176:177], v10 offset:8192
  ds_read_b64_tr_b16 a[178:179], v10 offset:8448
  ds_read_b64_tr_b16 a[180:181], v10 offset:8200
  ds_read_b64_tr_b16 a[182:183], v10 offset:8456
  ds_read_b64_tr_b16 a[184:185], v10 offset:10240
  ds_read_b64_tr_b16 a[186:187], v10 offset:10496
  ds_read_b64_tr_b16 a[188:189], v10 offset:10248
  ds_read_b64_tr_b16 a[190:191], v10 offset:10504
  s_waitcnt vmcnt(12)
  ds_read_b64_tr_b16 a[192:193], v10 offset:12288
  ds_read_b64_tr_b16 a[194:195], v10 offset:12544
  ds_read_b64_tr_b16 a[196:197], v10 offset:12296
  ds_read_b64_tr_b16 a[198:199], v10 offset:12552
  ds_read_b64_tr_b16 a[200:201], v10 offset:14336
  ds_read_b64_tr_b16 a[202:203], v10 offset:14592
  ds_read_b64_tr_b16 a[204:205], v10 offset:14344
  ds_read_b64_tr_b16 a[206:207], v10 offset:14600
  s_waitcnt vmcnt(8)
  ds_read_b64_tr_b16 a[208:209], v10 offset:16384
  ds_read_b64_tr_b16 a[210:211], v10 offset:16640
  ds_read_b64_tr_b16 a[212:213], v10 offset:16392
  ds_read_b64_tr_b16 a[214:215], v10 offset:16648
  ds_read_b64_tr_b16 a[216:217], v10 offset:18432
  ds_read_b64_tr_b16 a[218:219], v10 offset:18688
  ds_read_b64_tr_b16 a[220:221], v10 offset:18440
  ds_read_b64_tr_b16 a[222:223], v10 offset:18696
  s_waitcnt vmcnt(4)
  ds_read_b64_tr_b16 a[224:225], v10 offset:20480
  ds_read_b64_tr_b16 a[226:227], v10 offset:20736
  ds_read_b64_tr_b16 a[228:229], v10 offset:20488
  ds_read_b64_tr_b16 a[230:231], v10 offset:20744
  ds_read_b64_tr_b16 a[232:233], v10 offset:22528
  ds_read_b64_tr_b16 a[234:235], v10 offset:22784
  ds_read_b64_tr_b16 a[236:237], v10 offset:22536
  ds_read_b64_tr_b16 a[238:239], v10 offset:22792
  s_waitcnt vmcnt(0)
  ds_read_b64_tr_b16 a[240:241], v10 offset:24576
  ds_read_b64_tr_b16 a[242:243], v10 offset:24832
  ds_read_b64_tr_b16 a[244:245], v10 offset:24584
  ds_read_b64_tr_b16 a[246:247], v10 offset:24840
  ds_read_b64_tr_b16 a[248:249], v10 offset:26624
  ds_read_b64_tr_b16 a[250:251], v10 offset:26880
  ds_read_b64_tr_b16 a[252:253], v10 offset:26632
  ds_read_b64_tr_b16 a[254:255], v10 offset:26888
  s_waitcnt lgkmcnt(0)
  v_and_b32 v4, 31, v1
  v_lshlrev_b32 v8, 7, v4
  s_lshl_b32 s73, s54, 12
  s_add_u32 s73, s73, 89137152
  v_and_b32 v4, 15, v1
  v_mul_u32_u24 v9, 144, v4
  v_lshrrev_b32 v5, 4, v1
  v_lshl_add_u32 v9, v5, 5, v9
  s_mul_i32 s56, s52, 2304
  v_add_u32 v9, s56, v9
  v_mul_u32_u24 v10, 144, v5
  v_lshl_add_u32 v10, v4, 3, v10
  s_mul_i32 s56, s52, 576
  v_add_u32 v10, s56, v10
  v_lshlrev_b32 v11, 2, v0
  v_add_u32 v11, 0x20000, v11
  v_lshlrev_b32 v12, 10, v5
  v_lshl_add_u32 v12, v4, 2, v12
  s_and_b32 s56, s53, 1
  s_lshl_b32 s74, s56, 16
  s_lshl_b32 s56, s56, 14
  s_lshl_b32 s57, s52, 12
  s_add_u32 s56, s56, s57
  s_lshr_b32 s57, s53, 1
  s_lshl_b32 s57, s57, 6
  s_add_u32 s56, s56, s57
  v_add_u32 v12, s56, v12
  s_lshl_b32 s57, s54, 2
W_ARR2:
  buffer_load_dword v4, off, s[44:47], s57 offset:128 sc1
  s_sub_u32 s60, s60, 1
  s_cbranch_scc1 EXIT
  s_waitcnt vmcnt(0)
  v_cmp_gt_u32 vcc, 0x20000000, v4
  s_cbranch_vccnz W_ARR2
  s_mul_i32 s57, s55, s55
  s_lshl_b32 s57, s57, 8
  s_add_u32 s57, s57, s55
  s_add_u32 s57, s57, 0x1000000
  s_lshl_b32 s57, s57, 5
  v_readfirstlane_b32 s81, v4
  s_xor_b32 s81, s81, s57
GW_H:
  buffer_load_dword v4, v8, s[48:51], s73 offen sc1
  s_sub_u32 s60, s60, 1
  s_cbranch_scc1 EXIT
  s_waitcnt vmcnt(0)
  v_cmp_gt_u32 vcc, 1, v4
  s_cbranch_vccnz GW_H
  s_barrier
  s_mul_i32 s56, s52, 14336
  s_add_u32 s74, s74, s56
  s_lshl_b32 s56, s64, 17
  s_add_u32 s75, s74, s56
  s_add_u32 s75, s75, 61865984
  s_mov_b32 s66, 0
  v_mov_b32 v13, v9
DN_LOOP:
  s_add_u32 s56, s75, 0
  buffer_load_dwordx4 v[16:19], v2, s[48:51], s56 offen offset:0 sc1
  buffer_load_dwordx4 v[20:23], v2, s[48:51], s56 offen offset:1024 sc1
  buffer_load_dwordx4 v[24:27], v2, s[48:51], s56 offen offset:2048 sc1
  buffer_load_dwordx4 v[28:31], v2, s[48:51], s56 offen offset:3072 sc1
  s_add_u32 s56, s75, 4096
  buffer_load_dwordx4 v[32:35], v2, s[48:51], s56 offen offset:0 sc1
  buffer_load_dwordx4 v[36:39], v2, s[48:51], s56 offen offset:1024 sc1
  buffer_load_dwordx4 v[40:43], v2, s[48:51], s56 offen offset:2048 sc1
  buffer_load_dwordx4 v[44:47], v2, s[48:51], s56 offen offset:3072 sc1
  s_add_u32 s56, s75, 8192
  buffer_load_dwordx4 v[48:51], v2, s[48:51], s56 offen offset:0 sc1
  buffer_load_dwordx4 v[52:55], v2, s[48:51], s56 offen offset:1024 sc1
  buffer_load_dwordx4 v[56:59], v2, s[48:51], s56 offen offset:2048 sc1
  buffer_load_dwordx4 v[60:63], v2, s[48:51], s56 offen offset:3072 sc1
  s_add_u32 s56, s75, 12288
  buffer_load_dwordx4 v[64:67], v2, s[48:51], s56 offen offset:0 sc1
  buffer_load_dwordx4 v[68:71], v2, s[48:51], s56 offen offset:1024 sc1
  s_waitcnt vmcnt(13)
  v_mfma_f32_16x16x32_bf16 v[112:115], v[128:131], v[16:19], 0
  v_mfma_f32_16x16x32_bf16 v[116:119], v[132:135], v[16:19], 0
  s_waitcnt vmcnt(12)
  v_mfma_f32_16x16x32_bf16 v[112:115], v[136:139], v[20:23], v[112:115]
  v_mfma_f32_16x16x32_bf16 v[116:119], v[140:143], v[20:23], v[116:119]
  s_waitcnt vmcnt(11)
  v_mfma_f32_16x16x32_bf16 v[112:115], v[144:147], v[24:27], v[112:115]
  v_mfma_f32_16x16x32_bf16 v[116:119], v[148:151], v[24:27], v[116:119]
  s_waitcnt vmcnt(10)
  v_mfma_f32_16x16x32_bf16 v[112:115], v[152:155], v[28:31], v[112:115]
  v_mfma_f32_16x16x32_bf16 v[116:119], v[156:159], v[28:31], v[116:119]
  s_waitcnt vmcnt(9)
  v_mfma_f32_16x16x32_bf16 v[112:115], v[160:163], v[32:35], v[112:115]
  v_mfma_f32_16x16x32_bf16 v[116:119], v[164:167], v[32:35], v[116:119]
  s_waitcnt vmcnt(8)
  v_mfma_f32_16x16x32_bf16 v[112:115], v[168:171], v[36:39], v[112:115]
  v_mfma_f32_16x16x32_bf16 v[116:119], v[172:175], v[36:39], v[116:119]
  s_waitcnt vmcnt(7)
  v_mfma_f32_16x16x32_bf16 v[112:115], v[176:179], v[40:43], v[112:115]
  v_mfma_f32_16x16x32_bf16 v[116:119], v[180:183], v[40:43], v[116:119]
  s_waitcnt vmcnt(6)
  v_mfma_f32_16x16x32_bf16 v[112:115], v[184:187], v[44:47], v[112:115]
  v_mfma_f32_16x16x32_bf16 v[116:119], v[188:191], v[44:47], v[116:119]
  s_waitcnt vmcnt(5)
  v_mfma_f32_16x16x32_bf16 v[112:115], v[192:195], v[48:51], v[112:115]
  v_mfma_f32_16x16x32_bf16 v[116:119], v[196:199], v[48:51], v[116:119]
  s_waitcnt vmcnt(4)
  v_mfma_f32_16x16x32_bf16 v[112:115], v[200:203], v[52:55], v[112:115]
  v_mfma_f32_16x16x32_bf16 v[116:119], v[204:207], v[52:55], v[116:119]
  s_waitcnt vmcnt(3)
  v_mfma_f32_16x16x32_bf16 v[112:115], v[208:211], v[56:59], v[112:115]
  v_mfma_f32_16x16x32_bf16 v[116:119], v[212:215], v[56:59], v[116:119]
  s_waitcnt vmcnt(2)
  v_mfma_f32_16x16x32_bf16 v[112:115], v[216:219], v[60:63], v[112:115]
  v_mfma_f32_16x16x32_bf16 v[116:119], v[220:223], v[60:63], v[116:119]
  s_waitcnt vmcnt(1)
  v_mfma_f32_16x16x32_bf16 v[112:115], v[224:227], v[64:67], v[112:115]
  v_mfma_f32_16x16x32_bf16 v[116:119], v[228:231], v[64:67], v[116:119]
  s_waitcnt vmcnt(0)
  v_mfma_f32_16x16x32_bf16 v[112:115], v[232:235], v[68:71], v[112:115]
  s_nop 2
  v_mfma_f32_16x16x32_bf16 v[116:119], v[236:239], v[68:71], v[116:119]
  s_add_u32 s75, s75, 917504
  s_add_u32 s66, s66, 1
  s_cmp_lt_u32 s66, s65
  s_nop 0
  ds_write_b128 v13, v[112:115]
  s_nop 2
  ds_write_b128 v13, v[116:119] offset:16
  v_add_u32 v13, 9216, v13
  s_cbranch_scc1 DN_LOOP
  s_waitcnt lgkmcnt(0)
  s_barrier
  v_add_u32 v13, 46080, v10
  ds_read_b64 v[16:17], v10 offset:0
  ds_read_b64 v[18:19], v10 offset:2304
  ds_read_b64 v[20:21], v10 offset:4608
  ds_read_b64 v[22:23], v10 offset:6912
  ds_read_b64 v[24:25], v10 offset:9216
  ds_read_b64 v[26:27], v10 offset:11520
  ds_read_b64 v[28:29], v10 offset:13824
  ds_read_b64 v[30:31], v10 offset:16128
  ds_read_b64 v[32:33], v10 offset:18432
  ds_read_b64 v[34:35], v10 offset:20736
  ds_read_b64 v[36:37], v10 offset:23040
  ds_read_b64 v[38:39], v10 offset:25344
  ds_read_b64 v[40:41], v10 offset:27648
  ds_read_b64 v[42:43], v10 offset:29952
  ds_read_b64 v[44:45], v10 offset:32256
  ds_read_b64 v[46:47], v10 offset:34560
  ds_read_b64 v[48:49], v10 offset:36864
  ds_read_b64 v[50:51], v10 offset:39168
  ds_read_b64 v[52:53], v10 offset:41472
  ds_read_b64 v[54:55], v10 offset:43776
  ds_read_b64 v[56:57], v13 offset:0
  ds_read_b64 v[58:59], v13 offset:2304
  ds_read_b64 v[60:61], v13 offset:4608
  ds_read_b64 v[62:63], v13 offset:6912
  ds_read_b64 v[64:65], v13 offset:9216
  ds_read_b64 v[66:67], v13 offset:11520
  ds_read_b64 v[68:69], v13 offset:13824
  ds_read_b64 v[70:71], v13 offset:16128
  ds_read_b64 v[72:73], v13 offset:18432
  ds_read_b64 v[74:75], v13 offset:20736
  ds_read_b64 v[76:77], v13 offset:23040
  ds_read_b64 v[78:79], v13 offset:25344
  ds_read_b64 v[80:81], v13 offset:27648
  ds_read_b64 v[82:83], v13 offset:29952
  ds_read_b64 v[84:85], v13 offset:32256
  ds_read_b64 v[86:87], v13 offset:34560
  ds_read_b64 v[88:89], v13 offset:36864
  ds_read_b64 v[90:91], v13 offset:39168
  ds_read_b64 v[92:93], v13 offset:41472
  ds_read_b64 v[94:95], v13 offset:43776
  s_waitcnt lgkmcnt(0)
  v_add_f32 v16, v16, v18
  v_add_f32 v17, v17, v19
  v_add_f32 v20, v20, v22
  v_add_f32 v21, v21, v23
  v_add_f32 v16, v16, v20
  v_add_f32 v17, v17, v21
  v_cvt_pk_bf16_f32 v16, v16, v17
  v_and_b32 v17, 0xffff0000, v16
  v_lshlrev_b32 v16, 16, v16
  v_mul_f32 v18, 3216550459, v16
  v_mul_f32 v19, 3216550459, v17
  v_exp_f32 v18, v18
  v_exp_f32 v19, v19
  v_add_f32 v18, 1.0, v18
  v_add_f32 v19, 1.0, v19
  v_rcp_f32 v18, v18
  v_rcp_f32 v19, v19
  v_mul_f32 v16, v16, v18
  v_mul_f32 v17, v17, v19
  v_cvt_pk_bf16_f32 v16, v16, v17
  ds_write_b32 v11, v16 offset:0
  v_add_f32 v24, v24, v26
  v_add_f32 v25, v25, v27
  v_add_f32 v28, v28, v30
  v_add_f32 v29, v29, v31
  v_add_f32 v24, v24, v28
  v_add_f32 v25, v25, v29
  v_cvt_pk_bf16_f32 v24, v24, v25
  v_and_b32 v25, 0xffff0000, v24
  v_lshlrev_b32 v24, 16, v24
  v_mul_f32 v26, 3216550459, v24
  v_mul_f32 v27, 3216550459, v25
  v_exp_f32 v26, v26
  v_exp_f32 v27, v27
  v_add_f32 v26, 1.0, v26
  v_add_f32 v27, 1.0, v27
  v_rcp_f32 v26, v26
  v_rcp_f32 v27, v27
  v_mul_f32 v24, v24, v26
  v_mul_f32 v25, v25, v27
  v_cvt_pk_bf16_f32 v24, v24, v25
  ds_write_b32 v11, v24 offset:1024
  v_add_f32 v32, v32, v34
  v_add_f32 v33, v33, v35
  v_add_f32 v36, v36, v38
  v_add_f32 v37, v37, v39
  v_add_f32 v32, v32, v36
  v_add_f32 v33, v33, v37
  v_cvt_pk_bf16_f32 v32, v32, v33
  v_and_b32 v33, 0xffff0000, v32
  v_lshlrev_b32 v32, 16, v32
  v_mul_f32 v34, 3216550459, v32
  v_mul_f32 v35, 3216550459, v33
  v_exp_f32 v34, v34
  v_exp_f32 v35, v35
  v_add_f32 v34, 1.0, v34
  v_add_f32 v35, 1.0, v35
  v_rcp_f32 v34, v34
  v_rcp_f32 v35, v35
  v_mul_f32 v32, v32, v34
  v_mul_f32 v33, v33, v35
  v_cvt_pk_bf16_f32 v32, v32, v33
  ds_write_b32 v11, v32 offset:2048
  v_add_f32 v40, v40, v42
  v_add_f32 v41, v41, v43
  v_add_f32 v44, v44, v46
  v_add_f32 v45, v45, v47
  v_add_f32 v40, v40, v44
  v_add_f32 v41, v41, v45
  v_cvt_pk_bf16_f32 v40, v40, v41
  v_and_b32 v41, 0xffff0000, v40
  v_lshlrev_b32 v40, 16, v40
  v_mul_f32 v42, 3216550459, v40
  v_mul_f32 v43, 3216550459, v41
  v_exp_f32 v42, v42
  v_exp_f32 v43, v43
  v_add_f32 v42, 1.0, v42
  v_add_f32 v43, 1.0, v43
  v_rcp_f32 v42, v42
  v_rcp_f32 v43, v43
  v_mul_f32 v40, v40, v42
  v_mul_f32 v41, v41, v43
  v_cvt_pk_bf16_f32 v40, v40, v41
  ds_write_b32 v11, v40 offset:3072
  v_add_f32 v48, v48, v50
  v_add_f32 v49, v49, v51
  v_add_f32 v52, v52, v54
  v_add_f32 v53, v53, v55
  v_add_f32 v48, v48, v52
  v_add_f32 v49, v49, v53
  v_cvt_pk_bf16_f32 v48, v48, v49
  v_and_b32 v49, 0xffff0000, v48
  v_lshlrev_b32 v48, 16, v48
  v_mul_f32 v50, 3216550459, v48
  v_mul_f32 v51, 3216550459, v49
  v_exp_f32 v50, v50
  v_exp_f32 v51, v51
  v_add_f32 v50, 1.0, v50
  v_add_f32 v51, 1.0, v51
  v_rcp_f32 v50, v50
  v_rcp_f32 v51, v51
  v_mul_f32 v48, v48, v50
  v_mul_f32 v49, v49, v51
  v_cvt_pk_bf16_f32 v48, v48, v49
  ds_write_b32 v11, v48 offset:4096
  v_add_f32 v56, v56, v58
  v_add_f32 v57, v57, v59
  v_add_f32 v60, v60, v62
  v_add_f32 v61, v61, v63
  v_add_f32 v56, v56, v60
  v_add_f32 v57, v57, v61
  v_cvt_pk_bf16_f32 v56, v56, v57
  v_and_b32 v57, 0xffff0000, v56
  v_lshlrev_b32 v56, 16, v56
  v_mul_f32 v58, 3216550459, v56
  v_mul_f32 v59, 3216550459, v57
  v_exp_f32 v58, v58
  v_exp_f32 v59, v59
  v_add_f32 v58, 1.0, v58
  v_add_f32 v59, 1.0, v59
  v_rcp_f32 v58, v58
  v_rcp_f32 v59, v59
  v_mul_f32 v56, v56, v58
  v_mul_f32 v57, v57, v59
  v_cvt_pk_bf16_f32 v56, v56, v57
  ds_write_b32 v11, v56 offset:5120
  v_add_f32 v64, v64, v66
  v_add_f32 v65, v65, v67
  v_add_f32 v68, v68, v70
  v_add_f32 v69, v69, v71
  v_add_f32 v64, v64, v68
  v_add_f32 v65, v65, v69
  v_cvt_pk_bf16_f32 v64, v64, v65
  v_and_b32 v65, 0xffff0000, v64
  v_lshlrev_b32 v64, 16, v64
  v_mul_f32 v66, 3216550459, v64
  v_mul_f32 v67, 3216550459, v65
  v_exp_f32 v66, v66
  v_exp_f32 v67, v67
  v_add_f32 v66, 1.0, v66
  v_add_f32 v67, 1.0, v67
  v_rcp_f32 v66, v66
  v_rcp_f32 v67, v67
  v_mul_f32 v64, v64, v66
  v_mul_f32 v65, v65, v67
  v_cvt_pk_bf16_f32 v64, v64, v65
  ds_write_b32 v11, v64 offset:6144
  v_add_f32 v72, v72, v74
  v_add_f32 v73, v73, v75
  v_add_f32 v76, v76, v78
  v_add_f32 v77, v77, v79
  v_add_f32 v72, v72, v76
  v_add_f32 v73, v73, v77
  v_cvt_pk_bf16_f32 v72, v72, v73
  v_and_b32 v73, 0xffff0000, v72
  v_lshlrev_b32 v72, 16, v72
  v_mul_f32 v74, 3216550459, v72
  v_mul_f32 v75, 3216550459, v73
  v_exp_f32 v74, v74
  v_exp_f32 v75, v75
  v_add_f32 v74, 1.0, v74
  v_add_f32 v75, 1.0, v75
  v_rcp_f32 v74, v74
  v_rcp_f32 v75, v75
  v_mul_f32 v72, v72, v74
  v_mul_f32 v73, v73, v75
  v_cvt_pk_bf16_f32 v72, v72, v73
  ds_write_b32 v11, v72 offset:7168
  v_add_f32 v80, v80, v82
  v_add_f32 v81, v81, v83
  v_add_f32 v84, v84, v86
  v_add_f32 v85, v85, v87
  v_add_f32 v80, v80, v84
  v_add_f32 v81, v81, v85
  v_cvt_pk_bf16_f32 v80, v80, v81
  v_and_b32 v81, 0xffff0000, v80
  v_lshlrev_b32 v80, 16, v80
  v_mul_f32 v82, 3216550459, v80
  v_mul_f32 v83, 3216550459, v81
  v_exp_f32 v82, v82
  v_exp_f32 v83, v83
  v_add_f32 v82, 1.0, v82
  v_add_f32 v83, 1.0, v83
  v_rcp_f32 v82, v82
  v_rcp_f32 v83, v83
  v_mul_f32 v80, v80, v82
  v_mul_f32 v81, v81, v83
  v_cvt_pk_bf16_f32 v80, v80, v81
  ds_write_b32 v11, v80 offset:8192
  v_add_f32 v88, v88, v90
  v_add_f32 v89, v89, v91
  v_add_f32 v92, v92, v94
  v_add_f32 v93, v93, v95
  v_add_f32 v88, v88, v92
  v_add_f32 v89, v89, v93
  v_cvt_pk_bf16_f32 v88, v88, v89
  v_and_b32 v89, 0xffff0000, v88
  v_lshlrev_b32 v88, 16, v88
  v_mul_f32 v90, 3216550459, v88
  v_mul_f32 v91, 3216550459, v89
  v_exp_f32 v90, v90
  v_exp_f32 v91, v91
  v_add_f32 v90, 1.0, v90
  v_add_f32 v91, 1.0, v91
  v_rcp_f32 v90, v90
  v_rcp_f32 v91, v91
  v_mul_f32 v88, v88, v90
  v_mul_f32 v89, v89, v91
  v_cvt_pk_bf16_f32 v88, v88, v89
  ds_write_b32 v11, v88 offset:9216
  v_lshlrev_b32 v13, 4, v1
  s_lshl_b32 s56, s52, 12
  s_add_u32 s56, s56, 147456
  v_and_b32 v4, 15, v1
  v_lshrrev_b32 v5, 4, v1
  v_lshlrev_b32 v14, 6, v4
  v_lshl_add_u32 v14, v5, 4, v14
  v_add_u32 v14, s56, v14
  v_add_u32 v96, s56, v2
  s_lshr_b32 s56, s52, 1
  v_lshlrev_b32 v97, 8, v5
  v_bfe_u32 v6, v1, 1, 1
  v_lshl_add_u32 v97, v6, 12, v97
  v_bfe_u32 v6, v1, 2, 2
  v_lshl_add_u32 v97, v6, 5, v97
  v_and_b32 v6, 1, v1
  v_lshl_add_u32 v97, v6, 4, v97
  s_lshl_b32 s57, s56, 7
  v_add_u32 v97, s57, v97
  v_xor_b32 v98, 128, v97
  s_and_b32 s58, s52, 1
  s_lshl_b32 s59, s58, 4
  v_add_u32 v4, s59, v4
  v_lshlrev_b32 v5, 2, v5
  v_sub_u32 v4, v4, v5
  v_cmp_le_i32 s[86:87], 0, v4
  v_cmp_le_i32 s[88:89], 1, v4
  v_cmp_le_i32 s[90:91], 2, v4
  v_cmp_le_i32 s[92:93], 3, v4
  v_cmp_le_i32 s[94:95], 16, v4
  v_cmp_le_i32 s[96:97], 17, v4
  v_cmp_le_i32 s[98:99], 18, v4
  v_cmp_le_i32 s[100:101], 19, v4
  s_mov_b32 s80, 1040356334
  v_mov_b32 v15, 3492320863
  s_lshl_b32 s76, s58, 17
  s_lshl_b32 s82, s56, 11
  s_add_u32 s76, s76, s82
  s_lshl_b32 s57, s53, 12
  s_add_u32 s76, s76, s57
  s_add_u32 s76, s76, 70254592
  s_and_b32 s77, s53, 1
  s_lshl_b32 s77, s77, 17
  s_lshl_b32 s57, s52, 15
  s_add_u32 s77, s77, s57
  s_add_u32 s77, s77, 70254592
  s_lshl_b32 s75, s58, 10
  s_add_u32 s75, s75, 35651584
  s_mov_b32 s66, 0
  s_mov_b32 s67, s64
  s_lshl_b32 s56, s67, 18
  s_add_u32 s56, s56, s70
  s_lshl_b32 s57, s82, 1
  s_add_u32 s56, s56, s57
  s_add_u32 s57, s56, s75
  s_lshl_b32 s56, s56, 1
  s_add_u32 s56, s56, 2097152
  s_and_b32 s58, s56, 0xffffc000
  s_add_u32 s78, s58, 8192
  buffer_load_dwordx4 v[48:51], v13, s[48:51], s57 offen offset:0 sc1
  buffer_load_dwordx4 v[16:19], v97, s[48:51], s58 offen offset:0 sc1
  buffer_load_dwordx4 v[32:35], v97, s[48:51], s78 offen offset:0 sc1
  buffer_load_dwordx4 v[64:67], v13, s[48:51], s56 offen offset:2048 sc1
  buffer_load_dwordx4 v[68:71], v13, s[48:51], s56 offen offset:3072 sc1
  s_xor_b32 s56, s56, 4096
  buffer_load_dwordx4 v[52:55], v13, s[48:51], s57 offen offset:2048 sc1
  buffer_load_dwordx4 v[20:23], v97, s[48:51], s58 offen offset:1024 sc1
  buffer_load_dwordx4 v[36:39], v97, s[48:51], s78 offen offset:1024 sc1
  buffer_load_dwordx4 v[72:75], v13, s[48:51], s56 offen offset:2048 sc1
  buffer_load_dwordx4 v[76:79], v13, s[48:51], s56 offen offset:3072 sc1
  s_xor_b32 s57, s57, 4096
  buffer_load_dwordx4 v[56:59], v13, s[48:51], s57 offen offset:0 sc1
  buffer_load_dwordx4 v[24:27], v98, s[48:51], s58 offen offset:0 sc1
  buffer_load_dwordx4 v[40:43], v98, s[48:51], s78 offen offset:0 sc1
  buffer_load_dwordx4 v[60:63], v13, s[48:51], s57 offen offset:2048 sc1
  buffer_load_dwordx4 v[28:31], v98, s[48:51], s58 offen offset:1024 sc1
  buffer_load_dwordx4 v[44:47], v98, s[48:51], s78 offen offset:1024 sc1
  v_and_b32 v8, 0x380, v8
  s_lshl_b32 s56, s52, 10
  s_add_u32 s73, s73, s56
W5_LOOP:
  s_lshl_b32 s56, s67, 18
  s_add_u32 s57, s56, s70
  s_lshr_b32 s57, s57, 1
  s_add_u32 s57, s57, 53477376
  s_add_u32 s57, s57, s82
  s_xor_b32 s58, s57, 2048
  s_lshl_b32 s79, s67, 15
  s_and_b32 s56, s66, 1
  s_lshl1_add_u32 s56, s64, s56
  s_lshl_b32 s56, s56, 18
  s_add_u32 s59, s56, s77
  s_add_u32 s56, s56, s76
  buffer_load_dword v3, v12, s[4:7], s79 offen
  buffer_load_dwordx4 v[80:83], v13, s[48:51], s57 offen offset:0 sc1
  buffer_load_dwordx4 v[84:87], v13, s[48:51], s57 offen offset:1024 sc1
  buffer_load_dwordx4 v[88:91], v13, s[48:51], s58 offen offset:0 sc1
  buffer_load_dwordx4 v[92:95], v13, s[48:51], s58 offen offset:1024 sc1
  s_waitcnt vmcnt(5)
  v_mfma_f32_16x16x32_bf16 v[100:103], v[16:19], v[48:51], 0
  v_mfma_f32_16x16x32_bf16 v[104:107], v[32:35], v[48:51], 0
  v_mfma_f32_16x16x32_bf16 v[100:103], v[20:23], v[52:55], v[100:103]
  v_mfma_f32_16x16x32_bf16 v[104:107], v[36:39], v[52:55], v[104:107]
  v_mfma_f32_16x16x32_bf16 v[100:103], v[24:27], v[56:59], v[100:103]
  v_mfma_f32_16x16x32_bf16 v[104:107], v[40:43], v[56:59], v[104:107]
  v_mfma_f32_16x16x32_bf16 v[100:103], v[28:31], v[60:63], v[100:103]
  s_nop 2
  v_mfma_f32_16x16x32_bf16 v[104:107], v[44:47], v[60:63], v[104:107]
  s_nop 3
  v_cndmask_b32 v100, v15, v100, s[86:87]
  v_cndmask_b32 v101, v15, v101, s[88:89]
  v_cndmask_b32 v102, v15, v102, s[90:91]
  v_cndmask_b32 v103, v15, v103, s[92:93]
  v_cndmask_b32 v104, v15, v104, s[94:95]
  v_cndmask_b32 v105, v15, v105, s[96:97]
  v_cndmask_b32 v106, v15, v106, s[98:99]
  v_cndmask_b32 v107, v15, v107, s[100:101]
  v_max3_f32 v36, v100, v101, v102
  v_max3_f32 v5, v103, v104, v105
  v_max3_f32 v36, v36, v106, v107
  v_max_f32 v36, v36, v5
  v_mov_b32 v6, 0
  v_mov_b32 v5, v36
  s_nop 1
  v_permlane16_swap_b32 v36, v5
  v_max_f32 v36, v36, v5
  v_mov_b32 v5, v36
  s_nop 1
  v_permlane32_swap_b32 v36, v5
  v_max_f32 v36, v36, v5
  v_mul_f32 v36, s80, v36
  v_fma_f32 v100, v100, s80, -v36
  v_fma_f32 v101, v101, s80, -v36
  v_fma_f32 v102, v102, s80, -v36
  v_fma_f32 v103, v103, s80, -v36
  v_fma_f32 v104, v104, s80, -v36
  v_fma_f32 v105, v105, s80, -v36
  v_fma_f32 v106, v106, s80, -v36
  v_fma_f32 v107, v107, s80, -v36
  v_exp_f32 v100, v100
  v_exp_f32 v101, v101
  v_exp_f32 v102, v102
  v_exp_f32 v103, v103
  v_exp_f32 v104, v104
  v_exp_f32 v105, v105
  v_exp_f32 v106, v106
  v_exp_f32 v107, v107
  v_cvt_pk_bf16_f32 v32, v100, v101
  v_cvt_pk_bf16_f32 v33, v102, v103
  v_cvt_pk_bf16_f32 v34, v104, v105
  v_cvt_pk_bf16_f32 v35, v106, v107
  s_nop 1
  v_mfma_f32_16x16x32_bf16 v[112:115], v[64:67], v[32:35], 0
  v_mfma_f32_16x16x32_bf16 v[116:119], v[68:71], v[32:35], 0
  v_mfma_f32_16x16x32_bf16 v[120:123], v[72:75], v[32:35], 0
  v_mfma_f32_16x16x32_bf16 v[124:127], v[76:79], v[32:35], 0
  v_add_f32 v37, v100, v101
  v_add_f32 v5, v102, v103
  v_add_f32 v37, v37, v104
  v_add_f32 v5, v5, v105
  v_add_f32 v37, v37, v106
  v_add_f32 v5, v5, v107
  v_add_f32 v37, v37, v5
  s_branch W5_KC
W5_KP:
  buffer_load_dwordx4 v[80:83], v13, s[48:51], s57 offen offset:0 sc1
  buffer_load_dwordx4 v[84:87], v13, s[48:51], s57 offen offset:1024 sc1
  buffer_load_dwordx4 v[88:91], v13, s[48:51], s58 offen offset:0 sc1
  buffer_load_dwordx4 v[92:95], v13, s[48:51], s58 offen offset:1024 sc1
  s_sub_u32 s60, s60, 1
  s_cbranch_scc1 EXIT
W5_KC:
  s_waitcnt vmcnt(0)
  v_max3_u32 v4, v80, v84, v88
  v_max_u32 v4, v4, v92
  v_cmp_eq_u32 vcc, -1, v4
  s_cbranch_vccnz W5_KP
  ds_write_b128 v14, v[80:83] offset:0
  ds_read_b64_tr_b16 v[16:17], v96 offset:0
  ds_read_b64_tr_b16 v[18:19], v96 offset:8
  ds_write_b128 v14, v[84:87] offset:1024
  ds_read_b64_tr_b16 v[20:21], v96 offset:1024
  ds_read_b64_tr_b16 v[22:23], v96 offset:1032
  ds_write_b128 v14, v[88:91] offset:2048
  ds_read_b64_tr_b16 v[24:25], v96 offset:2048
  ds_read_b64_tr_b16 v[26:27], v96 offset:2056
  ds_write_b128 v14, v[92:95] offset:3072
  ds_read_b64_tr_b16 v[28:29], v96 offset:3072
  ds_read_b64_tr_b16 v[30:31], v96 offset:3080
  s_waitcnt lgkmcnt(9)
  v_mfma_f32_16x16x32_bf16 v[108:111], v[16:19], v[48:51], 0
  s_waitcnt lgkmcnt(6)
  v_mfma_f32_16x16x32_bf16 v[108:111], v[20:23], v[52:55], v[108:111]
  s_waitcnt lgkmcnt(3)
  v_mfma_f32_16x16x32_bf16 v[108:111], v[24:27], v[56:59], v[108:111]
  s_waitcnt lgkmcnt(0)
  v_mfma_f32_16x16x32_bf16 v[108:111], v[28:31], v[60:63], v[108:111]
  s_add_u32 s66, s66, 1
  s_add_u32 s69, s66, 1
  s_nop 5
  v_mul_f32 v108, s80, v108
  v_mul_f32 v109, s80, v109
  v_max3_f32 v4, v36, v108, v109
  v_mov_b32 v5, v4
  s_nop 1
  v_permlane16_swap_b32 v4, v5
  v_max_f32 v4, v4, v5
  v_mov_b32 v5, v4
  s_nop 1
  v_permlane32_swap_b32 v4, v5
  v_max_f32 v4, v4, v5
  v_sub_f32 v36, v36, v4
  v_sub_f32 v108, v108, v4
  v_sub_f32 v109, v109, v4
  v_exp_f32 v36, v36
  v_exp_f32 v108, v108
  v_exp_f32 v109, v109
  v_fma_f32 v4, v37, v36, v108
  v_add_f32 v4, v4, v109
  v_mov_b32 v5, v4
  s_nop 1
  v_permlane16_swap_b32 v4, v5
  v_add_f32 v4, v4, v5
  v_mov_b32 v5, v4
  s_nop 1
  v_permlane32_swap_b32 v4, v5
  v_add_f32 v4, v4, v5
  v_rcp_f32 v4, v4
  s_nop 0
  v_mul_f32 v36, v36, v4
  v_mul_f32 v108, v108, v4
  v_mul_f32 v109, v109, v4
  v_cvt_pk_bf16_f32 v7, v108, v109
  v_pk_mul_f32 v[112:113], v[112:113], v[36:37] op_sel_hi:[1,0]
  v_pk_mul_f32 v[114:115], v[114:115], v[36:37] op_sel_hi:[1,0]
  v_pk_mul_f32 v[116:117], v[116:117], v[36:37] op_sel_hi:[1,0]
  v_pk_mul_f32 v[118:119], v[118:119], v[36:37] op_sel_hi:[1,0]
  v_pk_mul_f32 v[120:121], v[120:121], v[36:37] op_sel_hi:[1,0]
  v_pk_mul_f32 v[122:123], v[122:123], v[36:37] op_sel_hi:[1,0]
  v_pk_mul_f32 v[124:125], v[124:125], v[36:37] op_sel_hi:[1,0]
  v_pk_mul_f32 v[126:127], v[126:127], v[36:37] op_sel_hi:[1,0]
  v_mfma_f32_16x16x16_bf16 v[112:115], v[80:81], v[6:7], v[112:115]
  s_nop 2
  v_mfma_f32_16x16x16_bf16 v[116:119], v[82:83], v[6:7], v[116:119]
  s_nop 1
  s_nop 0
  v_mfma_f32_16x16x16_bf16 v[120:123], v[84:85], v[6:7], v[120:123]
  s_nop 0
  s_nop 0
  v_mfma_f32_16x16x16_bf16 v[124:127], v[86:87], v[6:7], v[124:127]
  v_cvt_pk_bf16_f32 v100, v112, v113
  v_cvt_pk_bf16_f32 v101, v114, v115
  v_cvt_pk_bf16_f32 v102, v116, v117
  v_cvt_pk_bf16_f32 v103, v118, v119
  buffer_store_dwordx4 v[100:103], v2, s[48:51], s56 offen offset:0 sc1
  v_cvt_pk_bf16_f32 v104, v120, v121
  v_cvt_pk_bf16_f32 v105, v122, v123
  s_nop 0
  v_cvt_pk_bf16_f32 v106, v124, v125
  v_cvt_pk_bf16_f32 v107, v126, v127
  buffer_store_dwordx4 v[104:107], v2, s[48:51], s56 offen offset:1024 sc1
  ds_read_b32 v7, v11
  v_add_u32 v11, 1024, v11
  s_waitcnt vmcnt(0)
  s_barrier
  s_cmp_eq_u32 s52, 0
  s_cbranch_scc0 NOPUB_O
  v_mov_b32 v4, s69
  s_mov_b64 exec, 1
  buffer_store_dword v4, off, s[48:51], s72 sc1
  s_mov_b64 exec, -1
NOPUB_O:
GW_O:
  buffer_load_dword v4, v8, s[48:51], s73 offen sc1
  s_sub_u32 s60, s60, 1
  s_cbranch_scc1 EXIT
  s_waitcnt vmcnt(0)
  v_cmp_gt_u32 vcc, s69, v4
  s_cbranch_vccnz GW_O
  buffer_load_dwordx4 v[128:131], v2, s[48:51], s59 offen offset:0 sc1
  buffer_load_dwordx4 v[132:135], v2, s[48:51], s59 offen offset:1024 sc1
  buffer_load_dwordx4 v[136:139], v2, s[48:51], s59 offen offset:2048 sc1
  buffer_load_dwordx4 v[140:143], v2, s[48:51], s59 offen offset:3072 sc1
  s_add_u32 s59, s59, 4096
  buffer_load_dwordx4 v[144:147], v2, s[48:51], s59 offen offset:0 sc1
  buffer_load_dwordx4 v[148:151], v2, s[48:51], s59 offen offset:1024 sc1
  buffer_load_dwordx4 v[152:155], v2, s[48:51], s59 offen offset:2048 sc1
  buffer_load_dwordx4 v[156:159], v2, s[48:51], s59 offen offset:3072 sc1
  s_add_u32 s59, s59, 4096
  buffer_load_dwordx4 v[160:163], v2, s[48:51], s59 offen offset:0 sc1
  buffer_load_dwordx4 v[164:167], v2, s[48:51], s59 offen offset:1024 sc1
  buffer_load_dwordx4 v[168:171], v2, s[48:51], s59 offen offset:2048 sc1
  buffer_load_dwordx4 v[172:175], v2, s[48:51], s59 offen offset:3072 sc1
  s_add_u32 s59, s59, 4096
  buffer_load_dwordx4 v[176:179], v2, s[48:51], s59 offen offset:0 sc1
  buffer_load_dwordx4 v[180:183], v2, s[48:51], s59 offen offset:1024 sc1
  buffer_load_dwordx4 v[184:187], v2, s[48:51], s59 offen offset:2048 sc1
  buffer_load_dwordx4 v[188:191], v2, s[48:51], s59 offen offset:3072 sc1
  s_waitcnt vmcnt(15)
  v_mfma_f32_16x16x32_bf16 v[112:115], a[0:3], v[128:131], 0
  v_mfma_f32_16x16x32_bf16 v[116:119], a[4:7], v[128:131], 0
  s_add_u32 s59, s59, 4096
  buffer_load_dwordx4 v[192:195], v2, s[48:51], s59 offen offset:0 sc1
  s_waitcnt vmcnt(15)
  v_mfma_f32_16x16x32_bf16 v[112:115], a[8:11], v[132:135], v[112:115]
  v_mfma_f32_16x16x32_bf16 v[116:119], a[12:15], v[132:135], v[116:119]
  buffer_load_dwordx4 v[196:199], v2, s[48:51], s59 offen offset:1024 sc1
  s_waitcnt vmcnt(15)
  v_mfma_f32_16x16x32_bf16 v[112:115], a[16:19], v[136:139], v[112:115]
  v_mfma_f32_16x16x32_bf16 v[116:119], a[20:23], v[136:139], v[116:119]
  buffer_load_dwordx4 v[200:203], v2, s[48:51], s59 offen offset:2048 sc1
  s_waitcnt vmcnt(15)
  v_mfma_f32_16x16x32_bf16 v[112:115], a[24:27], v[140:143], v[112:115]
  v_mfma_f32_16x16x32_bf16 v[116:119], a[28:31], v[140:143], v[116:119]
  buffer_load_dwordx4 v[204:207], v2, s[48:51], s59 offen offset:3072 sc1
  s_waitcnt vmcnt(15)
  v_mfma_f32_16x16x32_bf16 v[112:115], a[32:35], v[144:147], v[112:115]
  v_mfma_f32_16x16x32_bf16 v[116:119], a[36:39], v[144:147], v[116:119]
  s_add_u32 s59, s59, 4096
  buffer_load_dwordx4 v[208:211], v2, s[48:51], s59 offen offset:0 sc1
  s_waitcnt vmcnt(15)
  v_mfma_f32_16x16x32_bf16 v[112:115], a[40:43], v[148:151], v[112:115]
  v_mfma_f32_16x16x32_bf16 v[116:119], a[44:47], v[148:151], v[116:119]
  buffer_load_dwordx4 v[212:215], v2, s[48:51], s59 offen offset:1024 sc1
  s_waitcnt vmcnt(15)
  v_mfma_f32_16x16x32_bf16 v[112:115], a[48:51], v[152:155], v[112:115]
  v_mfma_f32_16x16x32_bf16 v[116:119], a[52:55], v[152:155], v[116:119]
  buffer_load_dwordx4 v[216:219], v2, s[48:51], s59 offen offset:2048 sc1
  s_waitcnt vmcnt(15)
  v_mfma_f32_16x16x32_bf16 v[112:115], a[56:59], v[156:159], v[112:115]
  v_mfma_f32_16x16x32_bf16 v[116:119], a[60:63], v[156:159], v[116:119]
  buffer_load_dwordx4 v[220:223], v2, s[48:51], s59 offen offset:3072 sc1
  s_waitcnt vmcnt(15)
  v_mfma_f32_16x16x32_bf16 v[112:115], a[64:67], v[160:163], v[112:115]
  v_mfma_f32_16x16x32_bf16 v[116:119], a[68:71], v[160:163], v[116:119]
  s_add_u32 s59, s59, 4096
  buffer_load_dwordx4 v[224:227], v2, s[48:51], s59 offen offset:0 sc1
  s_waitcnt vmcnt(15)
  v_mfma_f32_16x16x32_bf16 v[112:115], a[72:75], v[164:167], v[112:115]
  v_mfma_f32_16x16x32_bf16 v[116:119], a[76:79], v[164:167], v[116:119]
  buffer_load_dwordx4 v[228:231], v2, s[48:51], s59 offen offset:1024 sc1
  s_waitcnt vmcnt(15)
  v_mfma_f32_16x16x32_bf16 v[112:115], a[80:83], v[168:171], v[112:115]
  v_mfma_f32_16x16x32_bf16 v[116:119], a[84:87], v[168:171], v[116:119]
  buffer_load_dwordx4 v[232:235], v2, s[48:51], s59 offen offset:2048 sc1
  s_waitcnt vmcnt(15)
  v_mfma_f32_16x16x32_bf16 v[112:115], a[88:91], v[172:175], v[112:115]
  v_mfma_f32_16x16x32_bf16 v[116:119], a[92:95], v[172:175], v[116:119]
  buffer_load_dwordx4 v[236:239], v2, s[48:51], s59 offen offset:3072 sc1
  s_waitcnt vmcnt(15)
  v_mfma_f32_16x16x32_bf16 v[112:115], a[96:99], v[176:179], v[112:115]
  v_mfma_f32_16x16x32_bf16 v[116:119], a[100:103], v[176:179], v[116:119]
  s_add_u32 s59, s59, 4096
  buffer_load_dwordx4 v[240:243], v2, s[48:51], s59 offen offset:0 sc1
  s_waitcnt vmcnt(15)
  v_mfma_f32_16x16x32_bf16 v[112:115], a[104:107], v[180:183], v[112:115]
  v_mfma_f32_16x16x32_bf16 v[116:119], a[108:111], v[180:183], v[116:119]
  buffer_load_dwordx4 v[244:247], v2, s[48:51], s59 offen offset:1024 sc1
  s_waitcnt vmcnt(15)
  v_mfma_f32_16x16x32_bf16 v[112:115], a[112:115], v[184:187], v[112:115]
  v_mfma_f32_16x16x32_bf16 v[116:119], a[116:119], v[184:187], v[116:119]
  buffer_load_dwordx4 v[248:251], v2, s[48:51], s59 offen offset:2048 sc1
  s_waitcnt vmcnt(15)
  v_mfma_f32_16x16x32_bf16 v[112:115], a[120:123], v[188:191], v[112:115]
  v_mfma_f32_16x16x32_bf16 v[116:119], a[124:127], v[188:191], v[116:119]
  buffer_load_dwordx4 v[252:255], v2, s[48:51], s59 offen offset:3072 sc1
  s_waitcnt vmcnt(15)
  v_mfma_f32_16x16x32_bf16 v[112:115], a[128:131], v[192:195], v[112:115]
  v_mfma_f32_16x16x32_bf16 v[116:119], a[132:135], v[192:195], v[116:119]
  s_waitcnt vmcnt(14)
  v_mfma_f32_16x16x32_bf16 v[112:115], a[136:139], v[196:199], v[112:115]
  v_mfma_f32_16x16x32_bf16 v[116:119], a[140:143], v[196:199], v[116:119]
  s_waitcnt vmcnt(13)
  v_mfma_f32_16x16x32_bf16 v[112:115], a[144:147], v[200:203], v[112:115]
  v_mfma_f32_16x16x32_bf16 v[116:119], a[148:151], v[200:203], v[116:119]
  s_waitcnt vmcnt(12)
  v_mfma_f32_16x16x32_bf16 v[112:115], a[152:155], v[204:207], v[112:115]
  v_mfma_f32_16x16x32_bf16 v[116:119], a[156:159], v[204:207], v[116:119]
  s_waitcnt vmcnt(11)
  v_mfma_f32_16x16x32_bf16 v[112:115], a[160:163], v[208:211], v[112:115]
  v_mfma_f32_16x16x32_bf16 v[116:119], a[164:167], v[208:211], v[116:119]
  s_waitcnt vmcnt(10)
  v_mfma_f32_16x16x32_bf16 v[112:115], a[168:171], v[212:215], v[112:115]
  v_mfma_f32_16x16x32_bf16 v[116:119], a[172:175], v[212:215], v[116:119]
  s_waitcnt vmcnt(9)
  v_mfma_f32_16x16x32_bf16 v[112:115], a[176:179], v[216:219], v[112:115]
  v_mfma_f32_16x16x32_bf16 v[116:119], a[180:183], v[216:219], v[116:119]
  s_waitcnt vmcnt(8)
  v_mfma_f32_16x16x32_bf16 v[112:115], a[184:187], v[220:223], v[112:115]
  v_mfma_f32_16x16x32_bf16 v[116:119], a[188:191], v[220:223], v[116:119]
  s_waitcnt vmcnt(7)
  v_mfma_f32_16x16x32_bf16 v[112:115], a[192:195], v[224:227], v[112:115]
  v_mfma_f32_16x16x32_bf16 v[116:119], a[196:199], v[224:227], v[116:119]
  s_waitcnt vmcnt(6)
  v_mfma_f32_16x16x32_bf16 v[112:115], a[200:203], v[228:231], v[112:115]
  v_mfma_f32_16x16x32_bf16 v[116:119], a[204:207], v[228:231], v[116:119]
  s_waitcnt vmcnt(5)
  v_mfma_f32_16x16x32_bf16 v[112:115], a[208:211], v[232:235], v[112:115]
  v_mfma_f32_16x16x32_bf16 v[116:119], a[212:215], v[232:235], v[116:119]
  s_waitcnt vmcnt(4)
  v_mfma_f32_16x16x32_bf16 v[112:115], a[216:219], v[236:239], v[112:115]
  v_mfma_f32_16x16x32_bf16 v[116:119], a[220:223], v[236:239], v[116:119]
  s_waitcnt vmcnt(3)
  v_mfma_f32_16x16x32_bf16 v[112:115], a[224:227], v[240:243], v[112:115]
  v_mfma_f32_16x16x32_bf16 v[116:119], a[228:231], v[240:243], v[116:119]
  s_waitcnt vmcnt(2)
  v_mfma_f32_16x16x32_bf16 v[112:115], a[232:235], v[244:247], v[112:115]
  v_mfma_f32_16x16x32_bf16 v[116:119], a[236:239], v[244:247], v[116:119]
  s_waitcnt vmcnt(1)
  v_mfma_f32_16x16x32_bf16 v[112:115], a[240:243], v[248:251], v[112:115]
  v_mfma_f32_16x16x32_bf16 v[116:119], a[244:247], v[248:251], v[116:119]
  s_waitcnt vmcnt(0)
  v_mfma_f32_16x16x32_bf16 v[112:115], a[248:251], v[252:255], v[112:115]
  s_nop 0
  v_mfma_f32_16x16x32_bf16 v[116:119], a[252:255], v[252:255], v[116:119]
  s_waitcnt lgkmcnt(0)
  v_and_b32 v6, 0xffff0000, v7
  v_lshlrev_b32 v7, 16, v7
  v_and_b32 v5, 0xffff0000, v3
  v_lshlrev_b32 v4, 16, v3
  s_add_u32 s67, s67, 7
  ds_write_b128 v9, v[112:115]
  s_nop 0
  ds_write_b128 v9, v[116:119] offset:16
  s_waitcnt lgkmcnt(0)
  s_barrier
  ds_read_b64 v[100:101], v10 offset:0
  ds_read_b64 v[102:103], v10 offset:2304
  ds_read_b64 v[104:105], v10 offset:4608
  ds_read_b64 v[106:107], v10 offset:6912
  s_waitcnt lgkmcnt(2)
  v_add_f32 v100, v100, v102
  v_add_f32 v101, v101, v103
  s_waitcnt lgkmcnt(0)
  v_add_f32 v104, v104, v106
  v_add_f32 v105, v105, v107
  v_add_f32 v100, v100, v104
  v_add_f32 v101, v101, v105
  v_cvt_pk_bf16_f32 v100, v100, v101
  v_and_b32 v101, 0xffff0000, v100
  v_lshlrev_b32 v100, 16, v100
  v_mul_f32 v100, v100, v7
  v_mul_f32 v101, v101, v6
  v_cvt_pk_bf16_f32 v100, v100, v101
  v_and_b32 v101, 0xffff0000, v100
  v_lshlrev_b32 v100, 16, v100
  v_add_f32 v100, v100, v4
  v_add_f32 v101, v101, v5
  v_cvt_pk_bf16_f32 v4, v100, v101
  buffer_store_dword v4, v12, s[40:43], s79 offen
  s_cmp_lt_u32 s66, s65
  s_cbranch_scc0 W5_END
  s_lshl_b32 s56, s67, 18
  s_add_u32 s56, s56, s70
  s_lshl_b32 s57, s82, 1
  s_add_u32 s56, s56, s57
  s_add_u32 s57, s56, s75
  s_lshl_b32 s56, s56, 1
  s_add_u32 s56, s56, 2097152
  s_and_b32 s58, s56, 0xffffc000
  s_add_u32 s78, s58, 8192
  buffer_load_dwordx4 v[48:51], v13, s[48:51], s57 offen offset:0 sc1
  buffer_load_dwordx4 v[16:19], v97, s[48:51], s58 offen offset:0 sc1
  buffer_load_dwordx4 v[32:35], v97, s[48:51], s78 offen offset:0 sc1
  buffer_load_dwordx4 v[64:67], v13, s[48:51], s56 offen offset:2048 sc1
  buffer_load_dwordx4 v[68:71], v13, s[48:51], s56 offen offset:3072 sc1
  s_xor_b32 s56, s56, 4096
  buffer_load_dwordx4 v[52:55], v13, s[48:51], s57 offen offset:2048 sc1
  buffer_load_dwordx4 v[20:23], v97, s[48:51], s58 offen offset:1024 sc1
  buffer_load_dwordx4 v[36:39], v97, s[48:51], s78 offen offset:1024 sc1
  buffer_load_dwordx4 v[72:75], v13, s[48:51], s56 offen offset:2048 sc1
  buffer_load_dwordx4 v[76:79], v13, s[48:51], s56 offen offset:3072 sc1
  s_xor_b32 s57, s57, 4096
  buffer_load_dwordx4 v[56:59], v13, s[48:51], s57 offen offset:0 sc1
  buffer_load_dwordx4 v[24:27], v98, s[48:51], s58 offen offset:0 sc1
  buffer_load_dwordx4 v[40:43], v98, s[48:51], s78 offen offset:0 sc1
  buffer_load_dwordx4 v[60:63], v13, s[48:51], s57 offen offset:2048 sc1
  buffer_load_dwordx4 v[28:31], v98, s[48:51], s58 offen offset:1024 sc1
  buffer_load_dwordx4 v[44:47], v98, s[48:51], s78 offen offset:1024 sc1
  s_branch W5_LOOP
W5_END:
  s_branch EXIT
CHAIN:
  v_mov_b32 v20, v1
  v_mov_b32 v21, v2
  s_mul_i32 s65, s52, 38912
  s_add_u32 s65, s65, 8192
  s_lshl_b32 s87, s52, 11
  s_add_u32 s56, s52, 0
  s_and_b32 s66, s56, 3
  s_add_u32 s56, s52, 1
  s_and_b32 s67, s56, 3
  s_add_u32 s56, s52, 2
  s_and_b32 s68, s56, 3
  s_add_u32 s56, s52, 3
  s_and_b32 s69, s56, 3
  v_lshrrev_b32 v22, 4, v20
  v_bfe_u32 v23, v20, 2, 1
  v_lshlrev_b32 v7, 8, v23
  v_bfe_u32 v23, v20, 1, 1
  v_lshl_add_u32 v7, v23, 5, v7
  v_and_b32 v23, 1, v20
  v_lshl_add_u32 v7, v23, 3, v7
  v_and_b32 v23, 1, v22
  v_lshl_add_u32 v7, v23, 4, v7
  v_lshrrev_b32 v24, 5, v20
  v_lshl_add_u32 v7, v24, 2, v7
  v_lshlrev_b32 v25, 10, v23
  v_lshl_add_u32 v25, v24, 2, v25
  v_and_b32 v24, 7, v20
  v_lshl_add_u32 v25, v24, 4, v25
  s_lshr_b32 s56, s53, 3
  s_bfe_u32 s57, s53, 0x20001
  s_and_b32 s58, s53, 1
  s_and_b32 s59, s52, 1
  s_lshl_b32 s71, s56, 11
  s_lshl_b32 s72, s59, 10
  s_add_u32 s71, s71, s72
  s_lshl_b32 s72, s58, 9
  s_add_u32 s71, s71, s72
  s_lshl_b32 s72, s57, 6
  s_add_u32 s71, s71, s72
  v_add_u32 v7, s71, v7
  s_lshl_b32 s57, s57, 11
  s_lshl_b32 s71, s56, 8
  s_add_u32 s57, s57, s71
  s_lshl_b32 s58, s58, 7
  s_add_u32 s57, s57, s58
  s_lshl_b32 s59, s59, 3
  s_add_u32 s57, s57, s59
  buffer_load_dword v28, v25, s[8:11], s57 offen
  v_lshrrev_b32 v23, 3, v20
  s_lshl_b32 s57, s52, 3
  v_add_u32 v23, s57, v23
  v_lshlrev_b32 v6, 13, v23
  v_lshl_add_u32 v6, v24, 4, v6
  v_and_b32 v23, 15, v23
  v_xor_b32 v23, s53, v23
  v_lshl_add_u32 v6, v23, 7, v6
  v_mov_b32 v24, -1
  v_mov_b32 v25, -1
  v_mov_b32 v26, -1
  v_mov_b32 v27, -1
  s_mov_b32 s71, 87031808
  s_mov_b32 s86, 87035904
  buffer_store_dwordx4 v[24:27], v6, s[48:51], s71 offen sc1
  buffer_store_dwordx4 v[24:27], v6, s[48:51], s86 offen sc1
  s_mov_b32 s56, 88088576
  buffer_store_dword v24, v7, s[48:51], s56 offen sc1
  s_mov_b32 s56, 88096768
  buffer_store_dword v24, v7, s[48:51], s56 offen sc1
  s_mov_b32 s56, 88104960
  buffer_store_dword v24, v7, s[48:51], s56 offen sc1
  v_and_b32 v23, 15, v20
  v_lshlrev_b32 v30, 12, v22
  v_lshl_add_u32 v30, v23, 4, v30
  s_lshl_b32 s56, s53, 17
  s_lshl_b32 s57, s52, 8
  s_add_u32 s56, s56, s57
  v_add_u32 v30, s56, v30
  s_lshl_b32 s56, s66, 15
  s_add_u32 s57, s56, 16384
  buffer_load_dwordx4 v[48:51], v30, s[24:27], s56 offen offset:0 nt
  buffer_load_dwordx4 v[52:55], v30, s[24:27], s56 offen offset:1024 nt
  buffer_load_dwordx4 v[56:59], v30, s[24:27], s56 offen offset:2048 nt
  buffer_load_dwordx4 v[60:63], v30, s[24:27], s56 offen offset:3072 nt
  buffer_load_dwordx4 v[64:67], v30, s[24:27], s57 offen offset:0 nt
  buffer_load_dwordx4 v[68:71], v30, s[24:27], s57 offen offset:1024 nt
  buffer_load_dwordx4 v[72:75], v30, s[24:27], s57 offen offset:2048 nt
  buffer_load_dwordx4 v[76:79], v30, s[24:27], s57 offen offset:3072 nt
  s_lshl_b32 s56, s67, 15
  s_add_u32 s57, s56, 16384
  buffer_load_dwordx4 v[80:83], v30, s[24:27], s56 offen offset:0 nt
  buffer_load_dwordx4 v[84:87], v30, s[24:27], s56 offen offset:1024 nt
  buffer_load_dwordx4 v[88:91], v30, s[24:27], s56 offen offset:2048 nt
  buffer_load_dwordx4 v[92:95], v30, s[24:27], s56 offen offset:3072 nt
  buffer_load_dwordx4 v[96:99], v30, s[24:27], s57 offen offset:0 nt
  buffer_load_dwordx4 v[100:103], v30, s[24:27], s57 offen offset:1024 nt
  buffer_load_dwordx4 v[104:107], v30, s[24:27], s57 offen offset:2048 nt
  buffer_load_dwordx4 v[108:111], v30, s[24:27], s57 offen offset:3072 nt
  v_and_b32 v31, 1, v22
  v_lshlrev_b32 v31, 4, v31
  v_lshrrev_b32 v32, 5, v20
  v_add_u32 v31, v31, v32
  v_lshlrev_b32 v31, 13, v31
  v_lshlrev_b32 v32, 2, v22
  v_xor_b32 v32, v32, v23
  v_lshl_add_u32 v31, v32, 4, v31
  s_lshl_b32 s56, s53, 8
  s_lshl_b32 s57, s52, 20
  s_add_u32 s56, s56, s57
  v_add_u32 v16, s56, v31
  s_lshl_b32 s88, s52, 12
  s_add_u32 s88, s88, 24576
  s_add_u32 m0, s88, 0
  s_mov_b32 s56, 0
  buffer_load_dwordx4 v16, s[12:15], s56 offen nt lds
  s_add_u32 m0, s88, 1024
  s_mov_b32 s56, 65536
  buffer_load_dwordx4 v16, s[12:15], s56 offen nt lds
  s_add_u32 m0, s88, 2048
  s_mov_b32 s56, 262144
  buffer_load_dwordx4 v16, s[12:15], s56 offen nt lds
  s_add_u32 m0, s88, 3072
  s_mov_b32 s56, 327680
  buffer_load_dwordx4 v16, s[12:15], s56 offen nt lds
  s_add_u32 m0, s88, 38912
  s_mov_b32 s56, 16384
  buffer_load_dwordx4 v16, s[12:15], s56 offen nt lds
  s_add_u32 m0, s88, 39936
  s_mov_b32 s56, 81920
  buffer_load_dwordx4 v16, s[12:15], s56 offen nt lds
  s_add_u32 m0, s88, 40960
  s_mov_b32 s56, 278528
  buffer_load_dwordx4 v16, s[12:15], s56 offen nt lds
  s_add_u32 m0, s88, 41984
  s_mov_b32 s56, 344064
  buffer_load_dwordx4 v16, s[12:15], s56 offen nt lds
  s_add_u32 m0, s88, 77824
  s_mov_b32 s56, 524288
  buffer_load_dwordx4 v16, s[12:15], s56 offen nt lds
  s_add_u32 m0, s88, 78848
  s_mov_b32 s56, 589824
  buffer_load_dwordx4 v16, s[12:15], s56 offen nt lds
  s_add_u32 m0, s88, 79872
  s_mov_b32 s56, 786432
  buffer_load_dwordx4 v16, s[12:15], s56 offen nt lds
  s_add_u32 m0, s88, 80896
  s_mov_b32 s56, 851968
  buffer_load_dwordx4 v16, s[12:15], s56 offen nt lds
  s_add_u32 m0, s88, 116736
  s_mov_b32 s56, 540672
  buffer_load_dwordx4 v16, s[12:15], s56 offen nt lds
  s_add_u32 m0, s88, 117760
  s_mov_b32 s56, 606208
  buffer_load_dwordx4 v16, s[12:15], s56 offen nt lds
  s_add_u32 m0, s88, 118784
  s_mov_b32 s56, 802816
  buffer_load_dwordx4 v16, s[12:15], s56 offen nt lds
  s_add_u32 m0, s88, 119808
  s_mov_b32 s56, 868352
  buffer_load_dwordx4 v16, s[12:15], s56 offen nt lds
  v_bfe_u32 v23, v20, 2, 2
  v_and_b32 v32, 3, v20
  v_lshlrev_b32 v31, 10, v22
  v_lshl_add_u32 v31, v23, 8, v31
  v_lshl_add_u32 v31, v32, 4, v31
  v_xor_b32 v23, s52, v23
  v_lshl_add_u32 v31, v23, 6, v31
  s_lshl_b32 s56, s66, 12
  s_add_u32 s56, s56, 24576
  v_add_u32 v112, s56, v31
  v_add_u32 v116, 77824, v112
  s_lshl_b32 s56, s67, 12
  s_add_u32 s56, s56, 24576
  v_add_u32 v113, s56, v31
  v_add_u32 v117, 77824, v113
  s_lshl_b32 s56, s68, 12
  s_add_u32 s56, s56, 24576
  v_add_u32 v114, s56, v31
  v_add_u32 v118, 77824, v114
  s_lshl_b32 s56, s69, 12
  s_add_u32 s56, s56, 24576
  v_add_u32 v115, s56, v31
  v_add_u32 v119, 77824, v115
  s_waitcnt vmcnt(37)
  v_min_u32 v28, -2, v28
  s_mov_b32 s56, 88080384
  buffer_store_dword v28, v7, s[48:51], s56 offen sc1
  v_lshlrev_b32 v1, 4, v20
  v_and_b32 v23, 2, v20
  v_cmp_eq_u32 vcc, 0, v23
  v_mov_b32 v23, 0xdddddddd
  v_mov_b32 v33, 0x88888888
  v_cndmask_b32 v0, v23, v33, vcc
  v_bfe_u32 v23, v20, 2, 2
  v_xor_b32 v23, v23, v22
  v_and_b32 v33, 15, v20
  v_lshlrev_b32 v33, 5, v33
  v_lshl_add_u32 v33, v23, 3, v33
  s_and_b32 s56, s52, 1
  s_lshl_b32 s56, s56, 10
  s_lshr_b32 s57, s52, 1
  s_lshl2_add_u32 s56, s57, s56
  s_add_u32 s56, s56, 4096
  v_add_u32 v3, s56, v33
  v_xor_b32 v33, v20, v22
  v_lshlrev_b32 v33, 3, v33
  v_add_u32 v4, 4096, v33
  s_lshl_b32 s56, s52, 2
  v_add_u32 v5, s56, v21
  v_lshlrev_b32 v2, 8, v22
  v_bfe_u32 v33, v20, 1, 1
  v_lshl_add_u32 v2, v33, 7, v2
  v_bfe_u32 v33, v20, 2, 2
  v_lshl_add_u32 v2, v33, 5, v2
  v_and_b32 v33, 1, v20
  v_lshl_add_u32 v2, v33, 4, v2
  s_mov_b32 s78, 1040356334
  s_mov_b32 s79, 1333788672
  s_mov_b32 s82, 0x3f803f80
  s_mov_b32 s83, 0x3f803f80
  s_mov_b32 s70, 0
  s_mov_b32 s64, 0
  s_mov_b32 s76, 0
  s_lshl_b32 s56, s53, 13
  s_and_b32 s57, s52, 1
  s_lshl_b32 s57, s57, 12
  s_add_u32 s57, s57, s56
  s_add_u32 s85, s57, 87031808
  s_add_u32 s57, s56, s87
  s_lshl_b32 s73, s57, 1
  s_add_u32 s73, s73, 2097152
  s_lshr_b32 s75, s57, 1
  s_add_u32 s75, s75, 53346304
  s_add_u32 s72, s87, 88080384
  s_lshl_b32 s77, s53, 7
  s_add_u32 s77, s77, 89128960
  s_and_b32 s92, s52, 1
  s_lshl_b32 s92, s92, 12
  s_cmp_lt_u32 s52, 2
  s_cselect_b32 s92, 0x40000000, s92
  s_mul_i32 s56, s66, 38912
  s_add_u32 s56, s56, 8192
  v_add_u32 v8, s56, v21
  s_mul_i32 s56, s67, 38912
  s_add_u32 s56, s56, 8192
  v_add_u32 v9, s56, v21
  s_mul_i32 s56, s68, 38912
  s_add_u32 s56, s56, 8192
  v_add_u32 v10, s56, v21
  s_mul_i32 s56, s69, 38912
  s_add_u32 s56, s56, 8192
  v_add_u32 v11, s56, v21
  v_mov_b32 v12, 0
  v_mov_b32 v13, 0
  v_mov_b32 v14, 0
  v_mov_b32 v15, 0
  v_lshlrev_b32 v23, 2, v20
  v_and_b32 v23, 16, v23
  v_mov_b32 v33, 0x3f80
  v_lshlrev_b32 v33, v23, v33
  v_bfe_u32 v23, v20, 3, 1
  v_and_b32 v34, 1, v20
  v_lshl_add_u32 v23, v23, 1, v34
  v_cmp_eq_u32 vcc, 0, v23
  s_nop 1
  v_cndmask_b32 v44, 0, v33, vcc
  v_cmp_eq_u32 vcc, 1, v23
  s_nop 1
  v_cndmask_b32 v45, 0, v33, vcc
  v_cmp_eq_u32 vcc, 2, v23
  s_nop 1
  v_cndmask_b32 v46, 0, v33, vcc
  v_cmp_eq_u32 vcc, 3, v23
  s_nop 1
  v_cndmask_b32 v47, 0, v33, vcc
  ds_write_b128 v1, v[44:47] offset:3072
  s_waitcnt vmcnt(17)
  v_mov_b32 v192, v48
  v_mov_b32 v193, v52
  v_mov_b32 v194, v56
  v_mov_b32 v195, v60
  v_mov_b32 v196, v64
  v_mov_b32 v197, v68
  v_mov_b32 v198, v72
  v_mov_b32 v199, v76
  v_mov_b32 v200, v49
  v_mov_b32 v201, v53
  v_mov_b32 v202, v57
  v_mov_b32 v203, v61
  v_mov_b32 v204, v65
  v_mov_b32 v205, v69
  v_mov_b32 v206, v73
  v_mov_b32 v207, v77
  v_mov_b32 v208, v50
  v_mov_b32 v209, v54
  v_mov_b32 v210, v58
  v_mov_b32 v211, v62
  v_mov_b32 v212, v66
  v_mov_b32 v213, v70
  v_mov_b32 v214, v74
  v_mov_b32 v215, v78
  v_mov_b32 v216, v51
  v_mov_b32 v217, v55
  v_mov_b32 v218, v59
  v_mov_b32 v219, v63
  v_mov_b32 v220, v67
  v_mov_b32 v221, v71
  v_mov_b32 v222, v75
  v_mov_b32 v223, v79
  v_mov_b32 v224, v80
  v_mov_b32 v225, v84
  v_mov_b32 v226, v88
  v_mov_b32 v227, v92
  v_mov_b32 v228, v96
  v_mov_b32 v229, v100
  v_mov_b32 v230, v104
  v_mov_b32 v231, v108
  v_mov_b32 v232, v81
  v_mov_b32 v233, v85
  v_mov_b32 v234, v89
  v_mov_b32 v235, v93
  v_mov_b32 v236, v97
  v_mov_b32 v237, v101
  v_mov_b32 v238, v105
  v_mov_b32 v239, v109
  v_mov_b32 v240, v82
  v_mov_b32 v241, v86
  v_mov_b32 v242, v90
  v_mov_b32 v243, v94
  v_mov_b32 v244, v98
  v_mov_b32 v245, v102
  v_mov_b32 v246, v106
  v_mov_b32 v247, v110
  v_mov_b32 v248, v83
  v_mov_b32 v249, v87
  v_mov_b32 v250, v91
  v_mov_b32 v251, v95
  v_mov_b32 v252, v99
  v_mov_b32 v253, v103
  v_mov_b32 v254, v107
  v_mov_b32 v255, v111
  s_waitcnt vmcnt(13)
  s_waitcnt lgkmcnt(0)
  s_barrier
  ds_read_b64_tr_b16 v[48:49], v112 offset:0
  ds_read_b64_tr_b16 v[56:57], v112 offset:8
  ds_read_b64_tr_b16 v[80:81], v113 offset:0
  ds_read_b64_tr_b16 v[88:89], v113 offset:8
  ds_read_b64_tr_b16 v[128:129], v114 offset:0
  ds_read_b64_tr_b16 v[136:137], v114 offset:8
  ds_read_b64_tr_b16 v[160:161], v115 offset:0
  ds_read_b64_tr_b16 v[168:169], v115 offset:8
  s_waitcnt vmcnt(9)
  s_waitcnt lgkmcnt(0)
  s_barrier
  s_add_u32 m0, s88, 0
  s_mov_b32 s56, 32768
  buffer_load_dwordx4 v16, s[12:15], s56 offen nt lds
  s_add_u32 m0, s88, 1024
  s_mov_b32 s56, 98304
  buffer_load_dwordx4 v16, s[12:15], s56 offen nt lds
  s_add_u32 m0, s88, 2048
  s_mov_b32 s56, 294912
  buffer_load_dwordx4 v16, s[12:15], s56 offen nt lds
  s_add_u32 m0, s88, 3072
  s_mov_b32 s56, 360448
  buffer_load_dwordx4 v16, s[12:15], s56 offen nt lds
  ds_read_b64_tr_b16 v[50:51], v112 offset:38912
  ds_read_b64_tr_b16 v[58:59], v112 offset:38920
  ds_read_b64_tr_b16 v[82:83], v113 offset:38912
  ds_read_b64_tr_b16 v[90:91], v113 offset:38920
  ds_read_b64_tr_b16 v[130:131], v114 offset:38912
  ds_read_b64_tr_b16 v[138:139], v114 offset:38920
  ds_read_b64_tr_b16 v[162:163], v115 offset:38912
  ds_read_b64_tr_b16 v[170:171], v115 offset:38920
  s_waitcnt vmcnt(9)
  s_waitcnt lgkmcnt(0)
  s_barrier
  s_add_u32 m0, s88, 38912
  s_mov_b32 s56, 49152
  buffer_load_dwordx4 v16, s[12:15], s56 offen nt lds
  s_add_u32 m0, s88, 39936
  s_mov_b32 s56, 114688
  buffer_load_dwordx4 v16, s[12:15], s56 offen nt lds
  s_add_u32 m0, s88, 40960
  s_mov_b32 s56, 311296
  buffer_load_dwordx4 v16, s[12:15], s56 offen nt lds
  s_add_u32 m0, s88, 41984
  s_mov_b32 s56, 376832
  buffer_load_dwordx4 v16, s[12:15], s56 offen nt lds
  ds_read_b64_tr_b16 v[52:53], v116 offset:0
  ds_read_b64_tr_b16 v[60:61], v116 offset:8
  ds_read_b64_tr_b16 v[84:85], v117 offset:0
  ds_read_b64_tr_b16 v[92:93], v117 offset:8
  ds_read_b64_tr_b16 v[132:133], v118 offset:0
  ds_read_b64_tr_b16 v[140:141], v118 offset:8
  ds_read_b64_tr_b16 v[164:165], v119 offset:0
  ds_read_b64_tr_b16 v[172:173], v119 offset:8
  s_waitcnt vmcnt(9)
  s_waitcnt lgkmcnt(0)
  s_barrier
  s_add_u32 m0, s88, 77824
  s_mov_b32 s56, 557056
  buffer_load_dwordx4 v16, s[12:15], s56 offen nt lds
  s_add_u32 m0, s88, 78848
  s_mov_b32 s56, 622592
  buffer_load_dwordx4 v16, s[12:15], s56 offen nt lds
  s_add_u32 m0, s88, 79872
  s_mov_b32 s56, 819200
  buffer_load_dwordx4 v16, s[12:15], s56 offen nt lds
  s_add_u32 m0, s88, 80896
  s_mov_b32 s56, 884736
  buffer_load_dwordx4 v16, s[12:15], s56 offen nt lds
  ds_read_b64_tr_b16 v[54:55], v116 offset:38912
  ds_read_b64_tr_b16 v[62:63], v116 offset:38920
  ds_read_b64_tr_b16 v[86:87], v117 offset:38912
  ds_read_b64_tr_b16 v[94:95], v117 offset:38920
  ds_read_b64_tr_b16 v[134:135], v118 offset:38912
  ds_read_b64_tr_b16 v[142:143], v118 offset:38920
  ds_read_b64_tr_b16 v[166:167], v119 offset:38912
  ds_read_b64_tr_b16 v[174:175], v119 offset:38920
  s_waitcnt vmcnt(8)
  s_waitcnt lgkmcnt(0)
  s_barrier
  s_add_u32 m0, s88, 116736
  s_mov_b32 s56, 573440
  buffer_load_dwordx4 v16, s[12:15], s56 offen nt lds
  s_add_u32 m0, s88, 117760
  s_mov_b32 s56, 638976
  buffer_load_dwordx4 v16, s[12:15], s56 offen nt lds
  s_add_u32 m0, s88, 118784
  s_mov_b32 s56, 835584
  buffer_load_dwordx4 v16, s[12:15], s56 offen nt lds
  s_add_u32 m0, s88, 119808
  s_mov_b32 s56, 901120
  buffer_load_dwordx4 v16, s[12:15], s56 offen nt lds
  ds_read_b64_tr_b16 v[64:65], v112 offset:0
  ds_read_b64_tr_b16 v[72:73], v112 offset:8
  ds_read_b64_tr_b16 v[96:97], v113 offset:0
  ds_read_b64_tr_b16 v[104:105], v113 offset:8
  ds_read_b64_tr_b16 v[144:145], v114 offset:0
  ds_read_b64_tr_b16 v[152:153], v114 offset:8
  ds_read_b64_tr_b16 v[176:177], v115 offset:0
  ds_read_b64_tr_b16 v[184:185], v115 offset:8
  s_cmp_eq_u32 s52, 3
  s_cbranch_scc0 C_NOH
  s_and_b32 s56, s55, 3
  s_lshl_b32 s56, s56, 3
  s_lshl_b32 s56, 4, s56
  s_and_b32 s57, s55, 4
  v_mov_b32 v23, s56
  s_mov_b64 exec, 1
  buffer_atomic_add v23, off, s[44:47], s57 offset:0
  s_mov_b64 exec, -1
C_NOH:
  s_waitcnt vmcnt(8)
  s_waitcnt lgkmcnt(0)
  s_barrier
  s_add_u32 m0, s88, 0
  s_mov_b32 s56, 0
  buffer_load_dwordx4 v16, s[16:19], s56 offen lds
  s_add_u32 m0, s88, 1024
  s_mov_b32 s56, 65536
  buffer_load_dwordx4 v16, s[16:19], s56 offen lds
  s_add_u32 m0, s88, 2048
  s_mov_b32 s56, 262144
  buffer_load_dwordx4 v16, s[16:19], s56 offen lds
  s_add_u32 m0, s88, 3072
  s_mov_b32 s56, 327680
  buffer_load_dwordx4 v16, s[16:19], s56 offen lds
  ds_read_b64_tr_b16 v[66:67], v112 offset:38912
  ds_read_b64_tr_b16 v[74:75], v112 offset:38920
  ds_read_b64_tr_b16 v[98:99], v113 offset:38912
  ds_read_b64_tr_b16 v[106:107], v113 offset:38920
  ds_read_b64_tr_b16 v[146:147], v114 offset:38912
  ds_read_b64_tr_b16 v[154:155], v114 offset:38920
  ds_read_b64_tr_b16 v[178:179], v115 offset:38912
  ds_read_b64_tr_b16 v[186:187], v115 offset:38920
  s_waitcnt vmcnt(8)
  s_waitcnt lgkmcnt(0)
  s_barrier
  s_add_u32 m0, s88, 38912
  s_mov_b32 s56, 16384
  buffer_load_dwordx4 v16, s[16:19], s56 offen lds
  s_add_u32 m0, s88, 39936
  s_mov_b32 s56, 81920
  buffer_load_dwordx4 v16, s[16:19], s56 offen lds
  s_add_u32 m0, s88, 40960
  s_mov_b32 s56, 278528
  buffer_load_dwordx4 v16, s[16:19], s56 offen lds
  s_add_u32 m0, s88, 41984
  s_mov_b32 s56, 344064
  buffer_load_dwordx4 v16, s[16:19], s56 offen lds
  ds_read_b64_tr_b16 v[68:69], v116 offset:0
  ds_read_b64_tr_b16 v[76:77], v116 offset:8
  ds_read_b64_tr_b16 v[100:101], v117 offset:0
  ds_read_b64_tr_b16 v[108:109], v117 offset:8
  ds_read_b64_tr_b16 v[148:149], v118 offset:0
  ds_read_b64_tr_b16 v[156:157], v118 offset:8
  ds_read_b64_tr_b16 v[180:181], v119 offset:0
  ds_read_b64_tr_b16 v[188:189], v119 offset:8
  s_waitcnt vmcnt(8)
  s_waitcnt lgkmcnt(0)
  s_barrier
  s_add_u32 m0, s88, 77824
  s_mov_b32 s56, 524288
  buffer_load_dwordx4 v16, s[16:19], s56 offen lds
  s_add_u32 m0, s88, 78848
  s_mov_b32 s56, 589824
  buffer_load_dwordx4 v16, s[16:19], s56 offen lds
  s_add_u32 m0, s88, 79872
  s_mov_b32 s56, 786432
  buffer_load_dwordx4 v16, s[16:19], s56 offen lds
  s_add_u32 m0, s88, 80896
  s_mov_b32 s56, 851968
  buffer_load_dwordx4 v16, s[16:19], s56 offen lds
  ds_read_b64_tr_b16 v[70:71], v116 offset:38912
  ds_read_b64_tr_b16 v[78:79], v116 offset:38920
  ds_read_b64_tr_b16 v[102:103], v117 offset:38912
  ds_read_b64_tr_b16 v[110:111], v117 offset:38920
  ds_read_b64_tr_b16 v[150:151], v118 offset:38912
  ds_read_b64_tr_b16 v[158:159], v118 offset:38920
  ds_read_b64_tr_b16 v[182:183], v119 offset:38912
  ds_read_b64_tr_b16 v[190:191], v119 offset:38920
  s_waitcnt vmcnt(8)
  s_waitcnt lgkmcnt(0)
  s_barrier
  s_add_u32 m0, s88, 116736
  s_mov_b32 s56, 540672
  buffer_load_dwordx4 v16, s[16:19], s56 offen lds
  s_add_u32 m0, s88, 117760
  s_mov_b32 s56, 606208
  buffer_load_dwordx4 v16, s[16:19], s56 offen lds
  s_add_u32 m0, s88, 118784
  s_mov_b32 s56, 802816
  buffer_load_dwordx4 v16, s[16:19], s56 offen lds
  s_add_u32 m0, s88, 119808
  s_mov_b32 s56, 868352
  buffer_load_dwordx4 v16, s[16:19], s56 offen lds
  ds_read_b64_tr_b16 a[0:1], v112 offset:0
  ds_read_b64_tr_b16 a[8:9], v112 offset:8
  ds_read_b64_tr_b16 a[32:33], v113 offset:0
  ds_read_b64_tr_b16 a[40:41], v113 offset:8
  ds_read_b64_tr_b16 a[64:65], v114 offset:0
  ds_read_b64_tr_b16 a[72:73], v114 offset:8
  ds_read_b64_tr_b16 a[96:97], v115 offset:0
  ds_read_b64_tr_b16 a[104:105], v115 offset:8
  ds_write_b128 v8, v[48:51] offset:0
  ds_write_b128 v8, v[52:55] offset:1024
  ds_write_b128 v8, v[56:59] offset:2048
  ds_write_b128 v8, v[60:63] offset:3072
  ds_write_b128 v8, v[64:67] offset:4096
  ds_write_b128 v8, v[68:71] offset:5120
  ds_write_b128 v8, v[72:75] offset:6144
  ds_write_b128 v8, v[76:79] offset:7168
  ds_write_b128 v8, v[80:83] offset:8192
  ds_write_b128 v8, v[84:87] offset:9216
  ds_write_b128 v8, v[88:91] offset:10240
  ds_write_b128 v8, v[92:95] offset:11264
  ds_write_b128 v8, v[96:99] offset:12288
  ds_write_b128 v8, v[100:103] offset:13312
  ds_write_b128 v8, v[104:107] offset:14336
  ds_write_b128 v8, v[108:111] offset:15360
  s_waitcnt vmcnt(8)
  s_waitcnt lgkmcnt(0)
  s_barrier
  s_add_u32 m0, s88, 0
  s_mov_b32 s56, 32768
  buffer_load_dwordx4 v16, s[16:19], s56 offen lds
  s_add_u32 m0, s88, 1024
  s_mov_b32 s56, 98304
  buffer_load_dwordx4 v16, s[16:19], s56 offen lds
  s_add_u32 m0, s88, 2048
  s_mov_b32 s56, 294912
  buffer_load_dwordx4 v16, s[16:19], s56 offen lds
  s_add_u32 m0, s88, 3072
  s_mov_b32 s56, 360448
  buffer_load_dwordx4 v16, s[16:19], s56 offen lds
  s_lshl_b32 s56, s68, 15
  s_add_u32 s57, s56, 16384
  buffer_load_dwordx4 v[48:51], v30, s[24:27], s56 offen offset:0 nt
  buffer_load_dwordx4 v[52:55], v30, s[24:27], s56 offen offset:1024 nt
  buffer_load_dwordx4 v[56:59], v30, s[24:27], s56 offen offset:2048 nt
  buffer_load_dwordx4 v[60:63], v30, s[24:27], s56 offen offset:3072 nt
  buffer_load_dwordx4 v[64:67], v30, s[24:27], s57 offen offset:0 nt
  buffer_load_dwordx4 v[68:71], v30, s[24:27], s57 offen offset:1024 nt
  buffer_load_dwordx4 v[72:75], v30, s[24:27], s57 offen offset:2048 nt
  buffer_load_dwordx4 v[76:79], v30, s[24:27], s57 offen offset:3072 nt
  s_lshl_b32 s56, s69, 15
  s_add_u32 s57, s56, 16384
  buffer_load_dwordx4 v[80:83], v30, s[24:27], s56 offen offset:0 nt
  buffer_load_dwordx4 v[84:87], v30, s[24:27], s56 offen offset:1024 nt
  buffer_load_dwordx4 v[88:91], v30, s[24:27], s56 offen offset:2048 nt
  buffer_load_dwordx4 v[92:95], v30, s[24:27], s56 offen offset:3072 nt
  buffer_load_dwordx4 v[96:99], v30, s[24:27], s57 offen offset:0 nt
  buffer_load_dwordx4 v[100:103], v30, s[24:27], s57 offen offset:1024 nt
  buffer_load_dwordx4 v[104:107], v30, s[24:27], s57 offen offset:2048 nt
  buffer_load_dwordx4 v[108:111], v30, s[24:27], s57 offen offset:3072 nt
  ds_read_b64_tr_b16 a[2:3], v112 offset:38912
  ds_read_b64_tr_b16 a[10:11], v112 offset:38920
  ds_read_b64_tr_b16 a[34:35], v113 offset:38912
  ds_read_b64_tr_b16 a[42:43], v113 offset:38920
  ds_read_b64_tr_b16 a[66:67], v114 offset:38912
  ds_read_b64_tr_b16 a[74:75], v114 offset:38920
  ds_read_b64_tr_b16 a[98:99], v115 offset:38912
  ds_read_b64_tr_b16 a[106:107], v115 offset:38920
  s_waitcnt vmcnt(24)
  s_waitcnt lgkmcnt(0)
  s_barrier
  s_add_u32 m0, s88, 38912
  s_mov_b32 s56, 49152
  buffer_load_dwordx4 v16, s[16:19], s56 offen lds
  s_add_u32 m0, s88, 39936
  s_mov_b32 s56, 114688
  buffer_load_dwordx4 v16, s[16:19], s56 offen lds
  s_add_u32 m0, s88, 40960
  s_mov_b32 s56, 311296
  buffer_load_dwordx4 v16, s[16:19], s56 offen lds
  s_add_u32 m0, s88, 41984
  s_mov_b32 s56, 376832
  buffer_load_dwordx4 v16, s[16:19], s56 offen lds
  ds_read_b64_tr_b16 a[4:5], v116 offset:0
  ds_read_b64_tr_b16 a[12:13], v116 offset:8
  ds_read_b64_tr_b16 a[36:37], v117 offset:0
  ds_read_b64_tr_b16 a[44:45], v117 offset:8
  ds_read_b64_tr_b16 a[68:69], v118 offset:0
  ds_read_b64_tr_b16 a[76:77], v118 offset:8
  ds_read_b64_tr_b16 a[100:101], v119 offset:0
  ds_read_b64_tr_b16 a[108:109], v119 offset:8
  s_waitcnt vmcnt(24)
  s_waitcnt lgkmcnt(0)
  s_barrier
  s_add_u32 m0, s88, 77824
  s_mov_b32 s56, 557056
  buffer_load_dwordx4 v16, s[16:19], s56 offen lds
  s_add_u32 m0, s88, 78848
  s_mov_b32 s56, 622592
  buffer_load_dwordx4 v16, s[16:19], s56 offen lds
  s_add_u32 m0, s88, 79872
  s_mov_b32 s56, 819200
  buffer_load_dwordx4 v16, s[16:19], s56 offen lds
  s_add_u32 m0, s88, 80896
  s_mov_b32 s56, 884736
  buffer_load_dwordx4 v16, s[16:19], s56 offen lds
  ds_read_b64_tr_b16 a[6:7], v116 offset:38912
  ds_read_b64_tr_b16 a[14:15], v116 offset:38920
  ds_read_b64_tr_b16 a[38:39], v117 offset:38912
  ds_read_b64_tr_b16 a[46:47], v117 offset:38920
  ds_read_b64_tr_b16 a[70:71], v118 offset:38912
  ds_read_b64_tr_b16 a[78:79], v118 offset:38920
  ds_read_b64_tr_b16 a[102:103], v119 offset:38912
  ds_read_b64_tr_b16 a[110:111], v119 offset:38920
  s_waitcnt vmcnt(24)
  s_waitcnt lgkmcnt(0)
  s_barrier
  s_add_u32 m0, s88, 116736
  s_mov_b32 s56, 573440
  buffer_load_dwordx4 v16, s[16:19], s56 offen lds
  s_add_u32 m0, s88, 117760
  s_mov_b32 s56, 638976
  buffer_load_dwordx4 v16, s[16:19], s56 offen lds
  s_add_u32 m0, s88, 118784
  s_mov_b32 s56, 835584
  buffer_load_dwordx4 v16, s[16:19], s56 offen lds
  s_add_u32 m0, s88, 119808
  s_mov_b32 s56, 901120
  buffer_load_dwordx4 v16, s[16:19], s56 offen lds
  ds_read_b64_tr_b16 a[16:17], v112 offset:0
  ds_read_b64_tr_b16 a[24:25], v112 offset:8
  ds_read_b64_tr_b16 a[48:49], v113 offset:0
  ds_read_b64_tr_b16 a[56:57], v113 offset:8
  ds_read_b64_tr_b16 a[80:81], v114 offset:0
  ds_read_b64_tr_b16 a[88:89], v114 offset:8
  ds_read_b64_tr_b16 a[112:113], v115 offset:0
  ds_read_b64_tr_b16 a[120:121], v115 offset:8
  s_waitcnt vmcnt(8)
  s_waitcnt lgkmcnt(0)
  s_barrier
  s_add_u32 m0, s88, 0
  s_mov_b32 s56, 0
  buffer_load_dwordx4 v16, s[20:23], s56 offen lds
  s_add_u32 m0, s88, 1024
  s_mov_b32 s56, 65536
  buffer_load_dwordx4 v16, s[20:23], s56 offen lds
  s_add_u32 m0, s88, 2048
  s_mov_b32 s56, 262144
  buffer_load_dwordx4 v16, s[20:23], s56 offen lds
  s_add_u32 m0, s88, 3072
  s_mov_b32 s56, 327680
  buffer_load_dwordx4 v16, s[20:23], s56 offen lds
  ds_read_b64_tr_b16 a[18:19], v112 offset:38912
  ds_read_b64_tr_b16 a[26:27], v112 offset:38920
  ds_read_b64_tr_b16 a[50:51], v113 offset:38912
  ds_read_b64_tr_b16 a[58:59], v113 offset:38920
  ds_read_b64_tr_b16 a[82:83], v114 offset:38912
  ds_read_b64_tr_b16 a[90:91], v114 offset:38920
  ds_read_b64_tr_b16 a[114:115], v115 offset:38912
  ds_read_b64_tr_b16 a[122:123], v115 offset:38920
  s_waitcnt vmcnt(8)
  s_waitcnt lgkmcnt(0)
  s_barrier
  s_add_u32 m0, s88, 38912
  s_mov_b32 s56, 16384
  buffer_load_dwordx4 v16, s[20:23], s56 offen lds
  s_add_u32 m0, s88, 39936
  s_mov_b32 s56, 81920
  buffer_load_dwordx4 v16, s[20:23], s56 offen lds
  s_add_u32 m0, s88, 40960
  s_mov_b32 s56, 278528
  buffer_load_dwordx4 v16, s[20:23], s56 offen lds
  s_add_u32 m0, s88, 41984
  s_mov_b32 s56, 344064
  buffer_load_dwordx4 v16, s[20:23], s56 offen lds
  ds_read_b64_tr_b16 a[20:21], v116 offset:0
  ds_read_b64_tr_b16 a[28:29], v116 offset:8
  ds_read_b64_tr_b16 a[52:53], v117 offset:0
  ds_read_b64_tr_b16 a[60:61], v117 offset:8
  ds_read_b64_tr_b16 a[84:85], v118 offset:0
  ds_read_b64_tr_b16 a[92:93], v118 offset:8
  ds_read_b64_tr_b16 a[116:117], v119 offset:0
  ds_read_b64_tr_b16 a[124:125], v119 offset:8
  s_waitcnt vmcnt(8)
  s_waitcnt lgkmcnt(0)
  s_barrier
  s_add_u32 m0, s88, 77824
  s_mov_b32 s56, 524288
  buffer_load_dwordx4 v16, s[20:23], s56 offen lds
  s_add_u32 m0, s88, 78848
  s_mov_b32 s56, 589824
  buffer_load_dwordx4 v16, s[20:23], s56 offen lds
  s_add_u32 m0, s88, 79872
  s_mov_b32 s56, 786432
  buffer_load_dwordx4 v16, s[20:23], s56 offen lds
  s_add_u32 m0, s88, 80896
  s_mov_b32 s56, 851968
  buffer_load_dwordx4 v16, s[20:23], s56 offen lds
  buffer_load_dwordx2 v[24:25], off, s[44:47], 0 offset:0 sc1
  buffer_load_dwordx4 v[32:35], off, s[44:47], 0 offset:128 sc1
  buffer_load_dwordx4 v[36:39], off, s[44:47], 0 offset:144 sc1
  ds_read_b64_tr_b16 a[22:23], v116 offset:38912
  ds_read_b64_tr_b16 a[30:31], v116 offset:38920
  ds_read_b64_tr_b16 a[54:55], v117 offset:38912
  ds_read_b64_tr_b16 a[62:63], v117 offset:38920
  ds_read_b64_tr_b16 a[86:87], v118 offset:38912
  ds_read_b64_tr_b16 a[94:95], v118 offset:38920
  ds_read_b64_tr_b16 a[118:119], v119 offset:38912
  ds_read_b64_tr_b16 a[126:127], v119 offset:38920
  s_waitcnt vmcnt(11)
  s_waitcnt lgkmcnt(0)
  s_barrier
  s_add_u32 m0, s88, 116736
  s_mov_b32 s56, 540672
  buffer_load_dwordx4 v16, s[20:23], s56 offen lds
  s_add_u32 m0, s88, 117760
  s_mov_b32 s56, 606208
  buffer_load_dwordx4 v16, s[20:23], s56 offen lds
  s_add_u32 m0, s88, 118784
  s_mov_b32 s56, 802816
  buffer_load_dwordx4 v16, s[20:23], s56 offen lds
  s_add_u32 m0, s88, 119808
  s_mov_b32 s56, 868352
  buffer_load_dwordx4 v16, s[20:23], s56 offen lds
  ds_read_b64_tr_b16 a[128:129], v112 offset:0
  ds_read_b64_tr_b16 a[136:137], v112 offset:8
  ds_read_b64_tr_b16 a[160:161], v113 offset:0
  ds_read_b64_tr_b16 a[168:169], v113 offset:8
  ds_read_b64_tr_b16 a[192:193], v114 offset:0
  ds_read_b64_tr_b16 a[200:201], v114 offset:8
  ds_read_b64_tr_b16 a[224:225], v115 offset:0
  ds_read_b64_tr_b16 a[232:233], v115 offset:8
  s_waitcnt vmcnt(11)
  s_waitcnt lgkmcnt(0)
  s_barrier
  s_add_u32 m0, s88, 0
  s_mov_b32 s56, 32768
  buffer_load_dwordx4 v16, s[20:23], s56 offen lds
  s_add_u32 m0, s88, 1024
  s_mov_b32 s56, 98304
  buffer_load_dwordx4 v16, s[20:23], s56 offen lds
  s_add_u32 m0, s88, 2048
  s_mov_b32 s56, 294912
  buffer_load_dwordx4 v16, s[20:23], s56 offen lds
  s_add_u32 m0, s88, 3072
  s_mov_b32 s56, 360448
  buffer_load_dwordx4 v16, s[20:23], s56 offen lds
  ds_read_b64_tr_b16 a[130:131], v112 offset:38912
  ds_read_b64_tr_b16 a[138:139], v112 offset:38920
  ds_read_b64_tr_b16 a[162:163], v113 offset:38912
  ds_read_b64_tr_b16 a[170:171], v113 offset:38920
  ds_read_b64_tr_b16 a[194:195], v114 offset:38912
  ds_read_b64_tr_b16 a[202:203], v114 offset:38920
  ds_read_b64_tr_b16 a[226:227], v115 offset:38912
  ds_read_b64_tr_b16 a[234:235], v115 offset:38920
  s_waitcnt vmcnt(11)
  s_waitcnt lgkmcnt(0)
  s_barrier
  s_add_u32 m0, s88, 38912
  s_mov_b32 s56, 49152
  buffer_load_dwordx4 v16, s[20:23], s56 offen lds
  s_add_u32 m0, s88, 39936
  s_mov_b32 s56, 114688
  buffer_load_dwordx4 v16, s[20:23], s56 offen lds
  s_add_u32 m0, s88, 40960
  s_mov_b32 s56, 311296
  buffer_load_dwordx4 v16, s[20:23], s56 offen lds
  s_add_u32 m0, s88, 41984
  s_mov_b32 s56, 376832
  buffer_load_dwordx4 v16, s[20:23], s56 offen lds
  ds_read_b64_tr_b16 a[132:133], v116 offset:0
  ds_read_b64_tr_b16 a[140:141], v116 offset:8
  ds_read_b64_tr_b16 a[164:165], v117 offset:0
  ds_read_b64_tr_b16 a[172:173], v117 offset:8
  ds_read_b64_tr_b16 a[196:197], v118 offset:0
  ds_read_b64_tr_b16 a[204:205], v118 offset:8
  ds_read_b64_tr_b16 a[228:229], v119 offset:0
  ds_read_b64_tr_b16 a[236:237], v119 offset:8
  s_waitcnt vmcnt(8)
  s_waitcnt lgkmcnt(0)
  s_barrier
  s_add_u32 m0, s88, 77824
  s_mov_b32 s56, 557056
  buffer_load_dwordx4 v16, s[20:23], s56 offen lds
  s_add_u32 m0, s88, 78848
  s_mov_b32 s56, 622592
  buffer_load_dwordx4 v16, s[20:23], s56 offen lds
  s_add_u32 m0, s88, 79872
  s_mov_b32 s56, 819200
  buffer_load_dwordx4 v16, s[20:23], s56 offen lds
  s_add_u32 m0, s88, 80896
  s_mov_b32 s56, 884736
  buffer_load_dwordx4 v16, s[20:23], s56 offen lds
  buffer_load_dwordx4 v[40:43], off, s[48:51], s77 sc1
  buffer_load_dwordx4 v[44:47], off, s[48:51], s77 offset:16 sc1
  ds_read_b64_tr_b16 a[134:135], v116 offset:38912
  ds_read_b64_tr_b16 a[142:143], v116 offset:38920
  ds_read_b64_tr_b16 a[166:167], v117 offset:38912
  ds_read_b64_tr_b16 a[174:175], v117 offset:38920
  ds_read_b64_tr_b16 a[198:199], v118 offset:38912
  ds_read_b64_tr_b16 a[206:207], v118 offset:38920
  ds_read_b64_tr_b16 a[230:231], v119 offset:38912
  ds_read_b64_tr_b16 a[238:239], v119 offset:38920
  s_waitcnt vmcnt(10)
  s_waitcnt lgkmcnt(0)
  s_barrier
  s_add_u32 m0, s88, 116736
  s_mov_b32 s56, 573440
  buffer_load_dwordx4 v16, s[20:23], s56 offen lds
  s_add_u32 m0, s88, 117760
  s_mov_b32 s56, 638976
  buffer_load_dwordx4 v16, s[20:23], s56 offen lds
  s_add_u32 m0, s88, 118784
  s_mov_b32 s56, 835584
  buffer_load_dwordx4 v16, s[20:23], s56 offen lds
  s_add_u32 m0, s88, 119808
  s_mov_b32 s56, 901120
  buffer_load_dwordx4 v16, s[20:23], s56 offen lds
  ds_read_b64_tr_b16 a[144:145], v112 offset:0
  ds_read_b64_tr_b16 a[152:153], v112 offset:8
  ds_read_b64_tr_b16 a[176:177], v113 offset:0
  ds_read_b64_tr_b16 a[184:185], v113 offset:8
  ds_read_b64_tr_b16 a[208:209], v114 offset:0
  ds_read_b64_tr_b16 a[216:217], v114 offset:8
  ds_read_b64_tr_b16 a[240:241], v115 offset:0
  ds_read_b64_tr_b16 a[248:249], v115 offset:8
  s_waitcnt vmcnt(10)
  s_waitcnt lgkmcnt(0)
  s_barrier
  ds_read_b64_tr_b16 a[146:147], v112 offset:38912
  ds_read_b64_tr_b16 a[154:155], v112 offset:38920
  ds_read_b64_tr_b16 a[178:179], v113 offset:38912
  ds_read_b64_tr_b16 a[186:187], v113 offset:38920
  ds_read_b64_tr_b16 a[210:211], v114 offset:38912
  ds_read_b64_tr_b16 a[218:219], v114 offset:38920
  ds_read_b64_tr_b16 a[242:243], v115 offset:38912
  ds_read_b64_tr_b16 a[250:251], v115 offset:38920
  s_waitcnt vmcnt(6)
  s_waitcnt lgkmcnt(0)
  s_barrier
  s_waitcnt vmcnt(4)
  s_add_u32 m0, s65, 34816
  s_nop 0
  buffer_load_dwordx4 v2, s[48:51], s73 offen offset:0 sc1 lds
  buffer_load_dwordx4 v2, s[48:51], s73 offen offset:1024 sc1 lds
  buffer_load_dwordx4 v1, s[48:51], s73 offen offset:2048 sc1 lds
  buffer_load_dwordx4 v1, s[48:51], s73 offen offset:3072 sc1 lds
  ds_read_b64_tr_b16 a[148:149], v116 offset:0
  ds_read_b64_tr_b16 a[156:157], v116 offset:8
  ds_read_b64_tr_b16 a[180:181], v117 offset:0
  ds_read_b64_tr_b16 a[188:189], v117 offset:8
  ds_read_b64_tr_b16 a[212:213], v118 offset:0
  ds_read_b64_tr_b16 a[220:221], v118 offset:8
  ds_read_b64_tr_b16 a[244:245], v119 offset:0
  ds_read_b64_tr_b16 a[252:253], v119 offset:8
  v_sad_u8 v26, v24, 0, 0
  v_sad_u8 v26, v25, 0, v26
  v_lshlrev_b32 v26, 22, v26
  v_min3_u32 v26, v26, v33, v34
  v_min3_u32 v26, v26, v35, v36
  v_min3_u32 v26, v26, v37, v38
  v_min_u32 v26, v26, v39
  v_or_b32 v24, v24, v25
  v_and_b32 v24, 0x80808080, v24
  v_mad_u32_u24 v41, v41, 7, 0
  v_mad_u32_u24 v42, v42, 7, 1
  v_mad_u32_u24 v43, v43, 7, 2
  v_mad_u32_u24 v44, v44, 7, 3
  v_mad_u32_u24 v45, v45, 7, 4
  v_mad_u32_u24 v46, v46, 7, 5
  v_mad_u32_u24 v47, v47, 7, 6
  v_min3_u32 v40, v41, v42, v43
  v_min3_u32 v40, v40, v44, v45
  v_min3_u32 v40, v40, v46, v47
  v_readfirstlane_b32 s56, v26
  v_readfirstlane_b32 s84, v24
  v_readfirstlane_b32 s70, v40
  s_cmp_lt_u32 s56, 0x20000000
  s_cselect_b32 s70, 0, s70
  s_waitcnt vmcnt(4)
  s_waitcnt lgkmcnt(0)
  s_barrier
  ds_read_b64_tr_b16 a[150:151], v116 offset:38912
  ds_read_b64_tr_b16 a[158:159], v116 offset:38920
  ds_read_b64_tr_b16 a[182:183], v117 offset:38912
  ds_read_b64_tr_b16 a[190:191], v117 offset:38920
  ds_read_b64_tr_b16 a[214:215], v118 offset:38912
  ds_read_b64_tr_b16 a[222:223], v118 offset:38920
  ds_read_b64_tr_b16 a[246:247], v119 offset:38912
  ds_read_b64_tr_b16 a[254:255], v119 offset:38920
  s_waitcnt lgkmcnt(0)
  s_barrier
  v_mov_b32 v32, v48
  v_mov_b32 v33, v52
  v_mov_b32 v34, v56
  v_mov_b32 v35, v60
  v_mov_b32 v36, v64
  v_mov_b32 v37, v68
  v_mov_b32 v38, v72
  v_mov_b32 v39, v76
  ds_write_b128 v8, v[32:35] offset:16384
  ds_write_b128 v8, v[36:39] offset:17408
  v_mov_b32 v40, v80
  v_mov_b32 v41, v84
  v_mov_b32 v42, v88
  v_mov_b32 v43, v92
  v_mov_b32 v44, v96
  v_mov_b32 v45, v100
  v_mov_b32 v46, v104
  v_mov_b32 v47, v108
  ds_write_b128 v8, v[40:43] offset:18432
  ds_write_b128 v8, v[44:47] offset:19456
  v_mov_b32 v32, v49
  v_mov_b32 v33, v53
  v_mov_b32 v34, v57
  v_mov_b32 v35, v61
  v_mov_b32 v36, v65
  v_mov_b32 v37, v69
  v_mov_b32 v38, v73
  v_mov_b32 v39, v77
  ds_write_b128 v8, v[32:35] offset:20480
  ds_write_b128 v8, v[36:39] offset:21504
  v_mov_b32 v40, v81
  v_mov_b32 v41, v85
  v_mov_b32 v42, v89
  v_mov_b32 v43, v93
  v_mov_b32 v44, v97
  v_mov_b32 v45, v101
  v_mov_b32 v46, v105
  v_mov_b32 v47, v109
  ds_write_b128 v8, v[40:43] offset:22528
  ds_write_b128 v8, v[44:47] offset:23552
  v_mov_b32 v32, v50
  v_mov_b32 v33, v54
  v_mov_b32 v34, v58
  v_mov_b32 v35, v62
  v_mov_b32 v36, v66
  v_mov_b32 v37, v70
  v_mov_b32 v38, v74
  v_mov_b32 v39, v78
  ds_write_b128 v8, v[32:35] offset:24576
  ds_write_b128 v8, v[36:39] offset:25600
  v_mov_b32 v40, v82
  v_mov_b32 v41, v86
  v_mov_b32 v42, v90
  v_mov_b32 v43, v94
  v_mov_b32 v44, v98
  v_mov_b32 v45, v102
  v_mov_b32 v46, v106
  v_mov_b32 v47, v110
  ds_write_b128 v8, v[40:43] offset:26624
  ds_write_b128 v8, v[44:47] offset:27648
  v_mov_b32 v32, v51
  v_mov_b32 v33, v55
  v_mov_b32 v34, v59
  v_mov_b32 v35, v63
  v_mov_b32 v36, v67
  v_mov_b32 v37, v71
  v_mov_b32 v38, v75
  v_mov_b32 v39, v79
  ds_write_b128 v8, v[32:35] offset:28672
  ds_write_b128 v8, v[36:39] offset:29696
  v_mov_b32 v40, v83
  v_mov_b32 v41, v87
  v_mov_b32 v42, v91
  v_mov_b32 v43, v95
  v_mov_b32 v44, v99
  v_mov_b32 v45, v103
  v_mov_b32 v46, v107
  v_mov_b32 v47, v111
  ds_write_b128 v8, v[40:43] offset:30720
  ds_write_b128 v8, v[44:47] offset:31744
  ds_read_b128 v[48:51], v8 offset:0
  ds_read_b128 v[52:55], v8 offset:1024
  ds_read_b128 v[88:91], v8 offset:2048
  ds_read_b128 v[92:95], v8 offset:3072
  ds_read_b128 v[96:99], v8 offset:4096
  ds_read_b128 v[100:103], v8 offset:5120
  ds_read_b128 v[72:75], v8 offset:6144
  ds_read_b128 v[76:79], v8 offset:7168
  ds_read_b128 v[80:83], v8 offset:8192
  ds_read_b128 v[84:87], v8 offset:9216
  s_cmp_gt_u32 s70, 1
  s_cbranch_scc1 C_GO
  s_mov_b32 s70, 0
  s_add_u32 m0, s65, 34816
C_W0:
  buffer_load_dwordx2 v[24:25], off, s[44:47], 0 offset:0 sc1
  buffer_load_dwordx4 v[28:31], off, s[44:47], 0 offset:128 sc1
  buffer_load_dwordx4 v[32:35], off, s[44:47], 0 offset:144 sc1
  s_sub_u32 s60, s60, 1
  s_cbranch_scc1 EXIT
  s_waitcnt vmcnt(0)
  v_sad_u8 v26, v24, 0, 0
  v_sad_u8 v26, v25, 0, v26
  v_lshlrev_b32 v26, 22, v26
  v_min3_u32 v26, v26, v29, v30
  v_min3_u32 v26, v26, v31, v32
  v_min3_u32 v26, v26, v33, v34
  v_min_u32 v26, v26, v35
  s_nop 0
  v_readfirstlane_b32 s56, v26
  s_cmp_lt_u32 s56, 0x20000000
  s_cbranch_scc1 C_W0
  v_or_b32 v24, v24, v25
  v_and_b32 v24, 0x80808080, v24
  s_nop 0
  v_readfirstlane_b32 s84, v24
  s_mov_b32 s59, 1
  s_cmp_gt_u32 s70, s59
  s_cbranch_scc1 RDY_OKI
RDY_PI:
  buffer_load_dwordx4 v[24:27], off, s[48:51], s77 sc1
  buffer_load_dwordx4 v[28:31], off, s[48:51], s77 offset:16 sc1
  s_sub_u32 s60, s60, 1
  s_cbranch_scc1 EXIT
  s_waitcnt vmcnt(0)
  v_mad_u32_u24 v25, v25, 7, 0
  v_mad_u32_u24 v26, v26, 7, 1
  v_mad_u32_u24 v27, v27, 7, 2
  v_mad_u32_u24 v28, v28, 7, 3
  v_mad_u32_u24 v29, v29, 7, 4
  v_mad_u32_u24 v30, v30, 7, 5
  v_mad_u32_u24 v31, v31, 7, 6
  v_min3_u32 v24, v25, v26, v27
  v_min3_u32 v24, v24, v28, v29
  v_min3_u32 v24, v24, v30, v31
  s_nop 0
  v_readfirstlane_b32 s70, v24
  s_cmp_gt_u32 s70, s59
  s_cbranch_scc0 RDY_PI
RDY_OKI:
  buffer_load_dwordx4 v2, s[48:51], s73 offen offset:0 sc1 lds
  buffer_load_dwordx4 v2, s[48:51], s73 offen offset:1024 sc1 lds
  buffer_load_dwordx4 v1, s[48:51], s73 offen offset:2048 sc1 lds
  buffer_load_dwordx4 v1, s[48:51], s73 offen offset:3072 sc1 lds
C_GO:
  s_add_u32 s73, s73, 0x80000
  s_waitcnt vmcnt(0)
  ds_read_b128 v[56:59], v8 offset:34816
  ds_read_b128 v[60:63], v8 offset:35840
  ds_read_b128 v[64:67], v8 offset:36864
  ds_read_b128 v[68:71], v8 offset:37888
  s_waitcnt lgkmcnt(0)
  s_barrier
  s_cmp_eq_u32 s84, 0
  s_cbranch_scc1 LOOPS
.p2align 6
  s_nop 0
  s_nop 0
  s_nop 0
LOOPF:
  s_nop 15
  s_nop 7
  buffer_load_dwordx4 v[16:19], v1, s[48:51], s72 offen sc1
  buffer_load_dwordx4 v[20:23], v1, s[48:51], s72 offen offset:1024 sc1
  v_mov_b64 v[104:105], 0
  v_mov_b64 v[106:107], 0
  v_mov_b64 v[108:109], 0
  v_mov_b64 v[110:111], 0
  s_waitcnt vmcnt(3) lgkmcnt(0)
  v_mov_b64 v[120:121], 0
  v_mov_b64 v[122:123], 0
  v_mov_b64 v[124:125], 0
  v_mov_b64 v[126:127], 0
  s_nop 15
  s_nop 5
MPF:
  buffer_load_dwordx4 v[16:19], v1, s[48:51], s72 offen sc1
  buffer_load_dwordx4 v[20:23], v1, s[48:51], s72 offen offset:1024 sc1
  s_sub_u32 s60, s60, 1
  s_cbranch_scc1 EXIT
  s_cmp_eq_u32 s64, 63
  v_mov_b64 v[116:117], 0
  v_mov_b64 v[118:119], 0
  v_mov_b64 v[112:113], 0
  v_mov_b64 v[114:115], 0
  s_waitcnt vmcnt(3)
  v_max3_u32 v25, v16, v17, v18
  v_max_u32 v25, v25, v19
  v_smfmac_f32_16x16x64_bf16 v[112:115], v[16:19], v[48:55], v0
  ds_write_b128 v8, v[16:19] offset:32768
  s_waitcnt vmcnt(2)
  v_max3_u32 v25, v25, v20, v21
  v_max3_u32 v25, v25, v22, v23
  v_cmp_eq_u32 vcc, -1, v25
  v_smfmac_f32_16x16x64_bf16 v[116:119], v[16:19], v[88:95], v0
  ds_write_b128 v8, v[20:23] offset:33792
  v_smfmac_f32_16x16x64_bf16 v[112:115], v[20:23], v[96:103], v0
  s_cbranch_vccnz MPF
  v_smfmac_f32_16x16x64_bf16 v[116:119], v[20:23], v[72:79], v0
  v_smfmac_f32_16x16x64_bf16 v[104:107], v[16:19], a[128:135], v0
  v_smfmac_f32_16x16x64_bf16 v[124:127], v[20:23], a[24:31], v0
  v_smfmac_f32_16x16x64_bf16 v[108:111], v[16:19], a[136:143], v0
  s_waitcnt lgkmcnt(0)
  s_barrier
  ds_read_b128 v[24:27], v9 offset:32768
  ds_read_b128 v[32:35], v10 offset:32768
  v_smfmac_f32_16x16x64_bf16 v[104:107], v[20:23], a[144:151], v0
  ds_read_b128 v[36:39], v10 offset:33792
  buffer_store_dwordx4 v[12:15], v1, s[48:51], s75 offen sc1
  v_smfmac_f32_16x16x64_bf16 v[108:111], v[20:23], a[152:159], v0
  ds_read_b128 v[40:43], v11 offset:32768
  v_smfmac_f32_16x16x64_bf16 v[120:123], v[16:19], a[0:7], v0
  ds_read_b128 v[44:47], v11 offset:33792
  v_smfmac_f32_16x16x64_bf16 v[124:127], v[16:19], a[8:15], v0
  ds_read_b128 v[28:31], v9 offset:33792
  s_cbranch_scc1 C_LAST
  s_waitcnt lgkmcnt(5)
  v_smfmac_f32_16x16x64_bf16 v[112:115], v[24:27], v[80:87], v0
  ds_read_b128 v[96:99], v8 offset:12288
  s_waitcnt lgkmcnt(5)
  v_smfmac_f32_16x16x64_bf16 v[112:115], v[32:35], v[128:135], v0
  ds_read_b128 v[100:103], v8 offset:13312
  s_waitcnt lgkmcnt(5)
  v_smfmac_f32_16x16x64_bf16 v[112:115], v[36:39], v[144:151], v0
  ds_read_b128 v[88:91], v8 offset:10240
  s_waitcnt lgkmcnt(5)
  v_smfmac_f32_16x16x64_bf16 v[112:115], v[40:43], v[160:167], v0
  ds_read_b128 v[92:95], v8 offset:11264
  s_waitcnt lgkmcnt(5)
  v_smfmac_f32_16x16x64_bf16 v[112:115], v[44:47], v[176:183], v0
  ds_read_b128 v[48:51], v8 offset:14336
  s_waitcnt lgkmcnt(3)
  v_smfmac_f32_16x16x64_bf16 v[112:115], v[28:31], v[96:103], v0
  ds_read_b128 v[52:55], v8 offset:15360
  s_nop 1
  v_smfmac_f32_16x16x64_bf16 v[116:119], v[32:35], v[136:143], v0
  ds_read_b128 v[72:75], v8 offset:16384
  s_nop 0
  v_smfmac_f32_16x16x64_bf16 v[116:119], v[36:39], v[152:159], v0
  ds_read_b128 v[76:79], v8 offset:17408
  v_add_f32 v112, v112, v114
  v_smfmac_f32_16x16x64_bf16 v[116:119], v[40:43], v[168:175], v0
  ds_read_b128 v[80:83], v8 offset:18432
  v_add_f32 v113, v113, v115
  s_waitcnt lgkmcnt(5)
  v_smfmac_f32_16x16x64_bf16 v[116:119], v[24:27], v[88:95], v0
  ds_read_b128 v[84:87], v8 offset:19456
  v_mul_f32 v112, s78, v112
  v_smfmac_f32_16x16x64_bf16 v[116:119], v[44:47], v[184:191], v0
  v_mul_f32 v113, s78, v113
  s_waitcnt lgkmcnt(4)
  v_smfmac_f32_16x16x64_bf16 v[116:119], v[28:31], v[48:55], v0
  ds_read_b128 v[88:91], v8 offset:20480
  v_cvt_pk_bf16_f32 v114, v112, v113
  v_smfmac_f32_16x16x64_bf16 v[120:123], v[20:23], a[16:23], v0
  ds_write_b32 v3, v114 offset:2048
  v_mov_b64 v[112:113], 0
  ds_read_b128 v[92:95], v8 offset:21504
  buffer_load_dwordx4 v2, s[48:51], s73 offen offset:0 sc1 lds
  v_smfmac_f32_16x16x64_bf16 v[120:123], v[24:27], a[32:39], v0
  v_add_f32 v116, v116, v118
  v_add_f32 v117, v117, v119
  v_mul_f32 v116, s78, v116
  v_mul_f32 v117, s78, v117
  v_cvt_pk_bf16_f32 v118, v116, v117
  ds_write_b32 v3, v118 offset:2560
  v_smfmac_f32_16x16x64_bf16 v[120:123], v[28:31], a[48:55], v0
  buffer_load_dwordx4 v2, s[48:51], s73 offen offset:1024 sc1 lds
  v_mov_b64 v[114:115], 0
  v_smfmac_f32_16x16x64_bf16 v[120:123], v[32:35], a[64:71], v0
  v_mov_b64 v[116:117], 0
  v_smfmac_f32_16x16x64_bf16 v[120:123], v[36:39], a[80:87], v0
  buffer_load_dwordx4 v1, s[48:51], s73 offen offset:2048 sc1 lds
  v_mov_b64 v[118:119], 0
  v_smfmac_f32_16x16x64_bf16 v[120:123], v[40:43], a[96:103], v0
  s_waitcnt lgkmcnt(0)
  s_barrier
  ds_read_b64_tr_b16 v[48:49], v4 offset:2048
  ds_read_b64_tr_b16 v[50:51], v4 offset:2560
  v_smfmac_f32_16x16x64_bf16 v[120:123], v[44:47], a[112:119], v0
  ds_read_b64_tr_b16 v[52:53], v4 offset:3072
  ds_read_b64_tr_b16 v[54:55], v4 offset:3584
  s_nop 0
  v_smfmac_f32_16x16x64_bf16 v[124:127], v[24:27], a[40:47], v0
  buffer_load_dwordx4 v1, s[48:51], s73 offen offset:3072 sc1 lds
  s_add_u32 s73, s73, 0x80000
  s_nop 0
  v_smfmac_f32_16x16x64_bf16 v[124:127], v[28:31], a[56:63], v0
  v_add_f32 v120, v120, v122
  v_smfmac_f32_16x16x64_bf16 v[124:127], v[32:35], a[72:79], v0
  s_waitcnt vmcnt(5) lgkmcnt(2)
  v_add_f32 v121, v121, v123
  v_mfma_f32_16x16x32_bf16 v[96:99], v[56:59], v[48:51], 0
  s_waitcnt lgkmcnt(0)
  v_cvt_pk_bf16_f32 v122, v120, v121
  v_mov_b64 v[20:21], s[82:83]
  v_mfma_f32_16x16x32_bf16 v[96:99], v[60:63], v[52:55], v[96:99]
  ds_write_b32 v3, v122 offset:0
  v_mov_b64 v[120:121], 0
  v_mov_b64 v[22:23], s[82:83]
  v_smfmac_f32_16x16x64_bf16 v[124:127], v[36:39], a[88:95], v0
  s_nop 1
  v_mov_b32 v18, 0
  v_smfmac_f32_16x16x64_bf16 v[124:127], v[40:43], a[104:111], v0
  v_add_f32_dpp v98, v96, v98 quad_perm:[0,1,0,1] row_mask:0xf bank_mask:0xf
  v_smfmac_f32_16x16x64_bf16 v[124:127], v[44:47], a[120:127], v0
  s_nop 1
  v_add_f32_dpp v99, v97, v99 quad_perm:[0,1,0,1] row_mask:0xf bank_mask:0xf
  v_smfmac_f32_16x16x64_bf16 v[104:107], v[24:27], a[160:167], v0
  s_nop 0
  v_exp_f32_dpp v96, v98 quad_perm:[2,3,2,3] row_mask:0xf bank_mask:0xf
  v_smfmac_f32_16x16x64_bf16 v[104:107], v[28:31], a[176:183], v0
  v_exp_f32_dpp v97, v99 quad_perm:[2,3,2,3] row_mask:0xf bank_mask:0xf
  v_add_f32 v124, v124, v126
  v_add_f32 v125, v125, v127
  v_cvt_pk_bf16_f32 v126, v124, v125
  ds_write_b32 v3, v126 offset:512
  v_cvt_pk_bf16_f32 v96, v96, v97
  v_smfmac_f32_16x16x64_bf16 v[104:107], v[32:35], a[192:199], v0
  ds_write_b32 v5, v96 offset:0
  v_mov_b64 v[124:125], 0
  v_smfmac_f32_16x16x64_bf16 v[104:107], v[36:39], a[208:215], v0
  v_smfmac_f32_16x16x64_bf16 v[104:107], v[40:43], a[224:231], v0
  v_smfmac_f32_16x16x64_bf16 v[104:107], v[44:47], a[240:247], v0
  v_smfmac_f32_16x16x64_bf16 v[108:111], v[24:27], a[168:175], v0
  s_waitcnt lgkmcnt(0)
  s_barrier
  ds_read_b64_tr_b16 v[56:57], v4 offset:0
  ds_read_b64_tr_b16 v[58:59], v4 offset:512
  v_smfmac_f32_16x16x64_bf16 v[108:111], v[28:31], a[184:191], v0
  ds_read_b64_tr_b16 v[60:61], v4 offset:1024
  ds_read_b64_tr_b16 v[62:63], v4 offset:1536
  v_add_f32 v104, v104, v106
  v_smfmac_f32_16x16x64_bf16 v[108:111], v[32:35], a[200:207], v0
  ds_read_b128 v[100:103], v1 offset:0
  v_add_f32 v105, v105, v107
  v_smfmac_f32_16x16x64_bf16 v[108:111], v[36:39], a[216:223], v0
  v_smfmac_f32_16x16x64_bf16 v[108:111], v[40:43], a[232:239], v0
  s_add_u32 s75, s75, 0x20000
  v_cvt_pk_bf16_f32 v13, v104, v105
  v_smfmac_f32_16x16x64_bf16 v[108:111], v[44:47], a[248:255], v0
  s_waitcnt lgkmcnt(3)
  v_min_u32 v12, -2, v122
  v_mfma_f32_16x16x32_bf16 v[24:27], v[56:59], v[48:51], 0
  s_waitcnt lgkmcnt(1)
  v_mov_b32 v14, v126
  v_mov_b64 v[122:123], 0
  v_mfma_f32_16x16x32_bf16 v[24:27], v[60:63], v[52:55], v[24:27]
  s_waitcnt lgkmcnt(0)
  v_mov_b64 v[126:127], 0
  v_add_f32 v108, v108, v110
  v_mfma_f32_16x16x32_bf16 v[28:31], v[20:23], v[100:103], 0
  ds_read_b128 v[48:51], v8 offset:22528
  v_add_f32 v109, v109, v111
  v_cvt_pk_bf16_f32 v15, v108, v109
  ds_read_b128 v[52:55], v8 offset:23552
  v_add_f32_dpp v26, v24, v26 quad_perm:[0,1,0,1] row_mask:0xf bank_mask:0xf
  v_add_f32_dpp v27, v25, v27 quad_perm:[0,1,0,1] row_mask:0xf bank_mask:0xf
  v_mfma_f32_16x16x32_bf16 v[32:35], v[64:67], v[100:103], 0
  v_exp_f32_dpp v24, v26 quad_perm:[2,3,2,3] row_mask:0xf bank_mask:0xf
  v_exp_f32_dpp v25, v27 quad_perm:[2,3,2,3] row_mask:0xf bank_mask:0xf
  v_mfma_f32_16x16x32_bf16 v[36:39], v[68:71], v[100:103], 0
  v_cvt_pk_bf16_f32 v19, v24, v25
  ds_read_b128 v[56:59], v8 offset:24576
  ds_read_b128 v[60:63], v8 offset:25600
  v_mfma_f32_16x16x16_bf16 v[28:31], v[20:21], v[18:19], v[28:31]
  ds_read_b128 v[104:107], v8 offset:26624
  s_nop 1
  v_mfma_f32_16x16x16_bf16 v[32:35], v[12:13], v[18:19], v[32:35]
  ds_read_b128 v[108:111], v8 offset:27648
  s_nop 1
  v_mfma_f32_16x16x16_bf16 v[36:39], v[14:15], v[18:19], v[36:39]
  v_rcp_f32 v30, v28
  s_nop 0
  v_max_f32 v28, v28, v30
  v_cmp_lt_f32 vcc, s79, v28
  v_pk_mul_f32 v[32:33], v[32:33], v[30:31] op_sel_hi:[1,0]
  v_pk_mul_f32 v[34:35], v[34:35], v[30:31] op_sel_hi:[1,0]
  v_cvt_pk_bf16_f32 v40, v32, v33
  v_cvt_pk_bf16_f32 v41, v34, v35
  v_pk_mul_f32 v[36:37], v[36:37], v[30:31] op_sel_hi:[1,0]
  v_pk_mul_f32 v[38:39], v[38:39], v[30:31] op_sel_hi:[1,0]
  v_cvt_pk_bf16_f32 v42, v36, v37
  v_cvt_pk_bf16_f32 v43, v38, v39
  ds_write_b128 v8, v[40:43] offset:32768
  s_cbranch_vccnz FBKF
FRETF:
  v_smfmac_f32_16x16x64_bf16 v[112:115], v[40:43], v[192:199], v0
  s_add_u32 s64, s64, 1
  s_and_b32 s56, s64, 3
  s_lshl_b32 s56, s56, 13
  v_smfmac_f32_16x16x64_bf16 v[116:119], v[40:43], v[200:207], v0
  s_add_u32 s74, s56, 88080384
  s_add_u32 s72, s74, s87
  s_xor_b32 s88, s74, 0x4000
  v_smfmac_f32_16x16x64_bf16 v[120:123], v[40:43], v[208:215], v0
  s_cmp_lt_u32 s52, 2
  s_waitcnt lgkmcnt(0)
  s_barrier
  ds_read_b128 v[64:67], v9 offset:32768
  ds_read_b128 v[68:71], v10 offset:32768
  ds_read_b128 v[24:27], v11 offset:32768
  v_smfmac_f32_16x16x64_bf16 v[124:127], v[40:43], v[216:223], v0
  ds_read_b128 v[96:99], v8 offset:28672
  ds_read_b128 v[100:103], v8 offset:29696
  s_waitcnt lgkmcnt(4)
  v_smfmac_f32_16x16x64_bf16 v[112:115], v[64:67], v[224:231], v0
  s_waitcnt lgkmcnt(3)
  v_smfmac_f32_16x16x64_bf16 v[112:115], v[68:71], v[72:79], v0
  s_waitcnt lgkmcnt(2)
  v_mov_b32 v42, -1
  v_smfmac_f32_16x16x64_bf16 v[112:115], v[24:27], v[80:87], v0
  ds_read_b128 v[16:19], v8 offset:30720
  s_nop 1
  v_smfmac_f32_16x16x64_bf16 v[116:119], v[64:67], v[232:239], v0
  ds_read_b128 v[20:23], v8 offset:31744
  s_nop 0
  v_smfmac_f32_16x16x64_bf16 v[116:119], v[68:71], v[88:95], v0
  ds_read_b128 v[44:47], v1 offset:3072
  v_cvt_pk_bf16_f32 v32, v112, v113
  v_smfmac_f32_16x16x64_bf16 v[116:119], v[24:27], v[48:55], v0
  s_nop 1
  v_and_or_b32 v32, v32, -2, s76
  v_smfmac_f32_16x16x64_bf16 v[120:123], v[64:67], v[240:247], v0
  s_nop 1
  v_cvt_pk_bf16_f32 v33, v114, v115
  v_smfmac_f32_16x16x64_bf16 v[120:123], v[68:71], v[56:63], v0
  v_cvt_pk_bf16_f32 v34, v116, v117
  v_cvt_pk_bf16_f32 v35, v118, v119
  buffer_store_dwordx4 v[32:35], v6, s[48:51], s71 offen
  v_smfmac_f32_16x16x64_bf16 v[120:123], v[24:27], v[104:111], v0
  s_waitcnt lgkmcnt(0)
  s_nop 1
  v_smfmac_f32_16x16x64_bf16 v[124:127], v[64:67], v[248:255], v0
  s_nop 2
  v_smfmac_f32_16x16x64_bf16 v[124:127], v[68:71], v[96:103], v0
  v_cvt_pk_bf16_f32 v36, v120, v121
  v_smfmac_f32_16x16x64_bf16 v[124:127], v[24:27], v[16:23], v0
  s_nop 1
  v_and_or_b32 v36, v36, -2, s76
  v_cvt_pk_bf16_f32 v37, v122, v123
  s_nop 3
  v_cvt_pk_bf16_f32 v38, v124, v125
  v_cvt_pk_bf16_f32 v39, v126, v127
  buffer_store_dwordx4 v[36:39], v6, s[48:51], s86 offen
  ds_read_b128 v[48:51], v8 offset:0
  ds_read_b128 v[52:55], v8 offset:1024
  ds_read_b128 v[88:91], v8 offset:2048
  ds_read_b128 v[92:95], v8 offset:3072
  ds_read_b128 v[96:99], v8 offset:4096
  ds_read_b128 v[100:103], v8 offset:5120
  ds_read_b128 v[72:75], v8 offset:6144
  ds_read_b128 v[76:79], v8 offset:7168
  ds_read_b128 v[80:83], v8 offset:8192
  ds_read_b128 v[84:87], v8 offset:9216
  s_cbranch_scc1 REDF
  s_waitcnt vmcnt(2)
  ds_read_b128 v[56:59], v8 offset:34816
  ds_read_b128 v[60:63], v8 offset:35840
  ds_read_b128 v[64:67], v8 offset:36864
  ds_read_b128 v[68:71], v8 offset:37888
  buffer_store_dword v42, v7, s[48:51], s88 offen
  s_cmp_eq_u32 s52, 3
  s_cbranch_scc0 JOINF
  s_add_u32 s59, s64, 1
  s_min_u32 s59, s59, 63
  s_cmp_gt_u32 s70, s59
  s_cbranch_scc1 RDY_OKF
RDY_PF:
  buffer_load_dwordx4 v[24:27], off, s[48:51], s77 sc1
  buffer_load_dwordx4 v[28:31], off, s[48:51], s77 offset:16 sc1
  s_sub_u32 s60, s60, 1
  s_cbranch_scc1 EXIT
  s_waitcnt vmcnt(0)
  v_mad_u32_u24 v25, v25, 7, 0
  v_mad_u32_u24 v26, v26, 7, 1
  v_mad_u32_u24 v27, v27, 7, 2
  v_mad_u32_u24 v28, v28, 7, 3
  v_mad_u32_u24 v29, v29, 7, 4
  v_mad_u32_u24 v30, v30, 7, 5
  v_mad_u32_u24 v31, v31, 7, 6
  v_min3_u32 v24, v25, v26, v27
  v_min3_u32 v24, v24, v28, v29
  v_min3_u32 v24, v24, v30, v31
  s_nop 0
  v_readfirstlane_b32 s70, v24
  s_cmp_gt_u32 s70, s59
  s_cbranch_scc0 RDY_PF
RDY_OKF:
JOINF:
  s_xor_b32 s76, s76, 1
  s_waitcnt lgkmcnt(0)
  s_barrier
  s_branch LOOPF
FBKF:
  v_mov_b32_dpp v98, v98 quad_perm:[2,3,2,3] row_mask:0xf bank_mask:0xf
  v_mov_b32_dpp v99, v99 quad_perm:[2,3,2,3] row_mask:0xf bank_mask:0xf
  v_mov_b32_dpp v26, v26 quad_perm:[2,3,2,3] row_mask:0xf bank_mask:0xf
  v_mov_b32_dpp v27, v27 quad_perm:[2,3,2,3] row_mask:0xf bank_mask:0xf
  ds_write_b32 v5, v98 offset:1024
  ds_write_b32 v5, v99 offset:2048
  s_waitcnt lgkmcnt(0)
  s_barrier
  ds_read_b128 v[32:35], v1 offset:1024
  ds_read_b128 v[36:39], v1 offset:2048
  v_max_f32 v28, v26, v27
  s_waitcnt lgkmcnt(0)
  v_max3_f32 v28, v28, v32, v33
  v_max3_f32 v28, v28, v34, v35
  v_max3_f32 v28, v28, v36, v37
  v_max3_f32 v28, v28, v38, v39
  v_mov_b32 v29, v28
  s_nop 1
  v_permlane16_swap_b32 v28, v29
  v_max_f32 v28, v28, v29
  v_mov_b32 v29, v28
  s_nop 1
  v_permlane32_swap_b32 v28, v29
  v_max_f32 v28, v28, v29
  v_sub_f32 v32, v32, v28
  v_sub_f32 v33, v33, v28
  v_sub_f32 v34, v34, v28
  v_sub_f32 v35, v35, v28
  v_sub_f32 v36, v36, v28
  v_sub_f32 v37, v37, v28
  v_sub_f32 v38, v38, v28
  v_sub_f32 v39, v39, v28
  v_sub_f32 v26, v26, v28
  v_sub_f32 v27, v27, v28
  v_exp_f32 v32, v32
  v_exp_f32 v33, v33
  v_exp_f32 v34, v34
  v_exp_f32 v35, v35
  v_exp_f32 v36, v36
  v_exp_f32 v37, v37
  v_exp_f32 v38, v38
  v_exp_f32 v39, v39
  v_cvt_pk_bf16_f32 v100, v32, v36
  v_cvt_pk_bf16_f32 v101, v33, v37
  v_cvt_pk_bf16_f32 v102, v34, v38
  v_cvt_pk_bf16_f32 v103, v35, v39
  s_nop 1
  v_mfma_f32_16x16x32_bf16 v[28:31], v[20:23], v[100:103], 0
  v_mfma_f32_16x16x32_bf16 v[32:35], v[64:67], v[100:103], 0
  v_exp_f32_dpp v24, v26 quad_perm:[2,3,2,3] row_mask:0xf bank_mask:0xf
  v_exp_f32_dpp v25, v27 quad_perm:[2,3,2,3] row_mask:0xf bank_mask:0xf
  v_mfma_f32_16x16x32_bf16 v[36:39], v[68:71], v[100:103], 0
  s_nop 0
  v_cvt_pk_bf16_f32 v19, v24, v25
  s_nop 1
  v_mfma_f32_16x16x16_bf16 v[28:31], v[20:21], v[18:19], v[28:31]
  s_nop 2
  v_mfma_f32_16x16x16_bf16 v[32:35], v[12:13], v[18:19], v[32:35]
  s_nop 2
  v_mfma_f32_16x16x16_bf16 v[36:39], v[14:15], v[18:19], v[36:39]
  v_rcp_f32 v30, v28
  s_nop 2
  v_pk_mul_f32 v[32:33], v[32:33], v[30:31] op_sel_hi:[1,0]
  v_pk_mul_f32 v[34:35], v[34:35], v[30:31] op_sel_hi:[1,0]
  v_cvt_pk_bf16_f32 v40, v32, v33
  v_cvt_pk_bf16_f32 v41, v34, v35
  v_pk_mul_f32 v[36:37], v[36:37], v[30:31] op_sel_hi:[1,0]
  v_pk_mul_f32 v[38:39], v[38:39], v[30:31] op_sel_hi:[1,0]
  v_cvt_pk_bf16_f32 v42, v36, v37
  v_cvt_pk_bf16_f32 v43, v38, v39
  ds_write_b128 v8, v[40:43] offset:32768
  s_branch FRETF
.p2align 6
REDF:
  s_cmp_eq_u32 s52, 0
  s_cbranch_scc1 PWF
  s_nop 13
PWF:
  s_nop 15
  s_nop 9
  s_waitcnt vmcnt(2)
PPF:
  buffer_load_dwordx4 v[24:27], v1, s[48:51], s85 offen offset:0 sc1
  buffer_load_dwordx4 v[28:31], v1, s[48:51], s85 offen offset:1024 sc1
  buffer_load_dwordx4 v[32:35], v1, s[48:51], s85 offen offset:2048 sc1
  buffer_load_dwordx4 v[36:39], v1, s[48:51], s85 offen offset:3072 sc1
  ds_read_b128 v[56:59], v8 offset:34816
  ds_read_b128 v[60:63], v8 offset:35840
  ds_read_b128 v[64:67], v8 offset:36864
  ds_read_b128 v[68:71], v8 offset:37888
  s_nop 15
  s_nop 15
PQF:
  buffer_load_dwordx4 v[112:115], v1, s[48:51], s85 offen offset:0 sc1
  buffer_load_dwordx4 v[116:119], v1, s[48:51], s85 offen offset:1024 sc1
  buffer_load_dwordx4 v[120:123], v1, s[48:51], s85 offen offset:2048 sc1
  buffer_load_dwordx4 v[124:127], v1, s[48:51], s85 offen offset:3072 sc1
  s_waitcnt vmcnt(7)
  v_mfma_f32_16x16x32_bf16 v[20:23], v[44:47], v[24:27], 0
  s_waitcnt vmcnt(6)
  v_mfma_f32_16x16x32_bf16 v[20:23], v[44:47], v[28:31], v[20:23]
  v_bitop3_b32 v40, v24, v28, s76 bitop3:0x7e
  s_waitcnt vmcnt(5)
  v_mfma_f32_16x16x32_bf16 v[20:23], v[44:47], v[32:35], v[20:23]
  s_waitcnt vmcnt(4)
  v_mfma_f32_16x16x32_bf16 v[20:23], v[44:47], v[36:39], v[20:23]
  s_nop 0
  v_bitop3_b32 v41, v32, v36, s76 bitop3:0x7e
  v_bitop3_b32 v40, v40, 1, v41 bitop3:0xc8
  v_cmp_ne_u32 vcc, 0, v40
  s_nop 3
  v_add_f32_dpp v20, v20, v20 row_ror:8 row_mask:0xf bank_mask:0xf
  v_add_f32_dpp v21, v21, v21 row_ror:8 row_mask:0xf bank_mask:0xf
  v_cvt_pk_bf16_f32 v41, v20, v21
  v_min_u32 v41, -2, v41
  s_cbranch_vccnz PFF
PDF:
  buffer_store_dword v41, v7, s[48:51], s74 offen
  s_barrier
  s_xor_b32 s76, s76, 1
  s_branch LOOPF
.p2align 6
PFF:
  buffer_load_dwordx4 v[24:27], v1, s[48:51], s85 offen offset:0 sc1
  buffer_load_dwordx4 v[28:31], v1, s[48:51], s85 offen offset:1024 sc1
  buffer_load_dwordx4 v[32:35], v1, s[48:51], s85 offen offset:2048 sc1
  buffer_load_dwordx4 v[36:39], v1, s[48:51], s85 offen offset:3072 sc1
  s_waitcnt vmcnt(7)
  v_mfma_f32_16x16x32_bf16 v[20:23], v[44:47], v[112:115], 0
  s_waitcnt vmcnt(6)
  v_mfma_f32_16x16x32_bf16 v[20:23], v[44:47], v[116:119], v[20:23]
  v_bitop3_b32 v40, v112, v116, s76 bitop3:0x7e
  s_waitcnt vmcnt(5)
  v_mfma_f32_16x16x32_bf16 v[20:23], v[44:47], v[120:123], v[20:23]
  s_waitcnt vmcnt(4)
  v_mfma_f32_16x16x32_bf16 v[20:23], v[44:47], v[124:127], v[20:23]
  s_nop 0
  v_bitop3_b32 v41, v120, v124, s76 bitop3:0x7e
  v_bitop3_b32 v40, v40, 1, v41 bitop3:0xc8
  v_cmp_ne_u32 vcc, 0, v40
  s_nop 3
  v_add_f32_dpp v20, v20, v20 row_ror:8 row_mask:0xf bank_mask:0xf
  v_add_f32_dpp v21, v21, v21 row_ror:8 row_mask:0xf bank_mask:0xf
  v_cvt_pk_bf16_f32 v41, v20, v21
  v_min_u32 v41, -2, v41
  s_cbranch_vccnz PGF
  buffer_store_dword v41, v7, s[48:51], s74 offen
  s_barrier
  s_xor_b32 s76, s76, 1
  s_branch LOOPF
PGF:
  s_sub_u32 s60, s60, 1
  s_cbranch_scc1 EXIT
  s_branch PQF
LOOPS:
  s_nop 15
  s_nop 7
  buffer_load_dwordx4 v[16:19], v1, s[48:51], s72 offen sc1
  buffer_load_dwordx4 v[20:23], v1, s[48:51], s72 offen offset:1024 sc1
  v_mov_b64 v[104:105], 0
  v_mov_b64 v[106:107], 0
  v_mov_b64 v[108:109], 0
  v_mov_b64 v[110:111], 0
  s_waitcnt vmcnt(3) lgkmcnt(0)
  v_mov_b64 v[120:121], 0
  v_mov_b64 v[122:123], 0
  v_mov_b64 v[124:125], 0
  v_mov_b64 v[126:127], 0
  s_nop 15
  s_nop 5
MPS:
  buffer_load_dwordx4 v[16:19], v1, s[48:51], s72 offen sc1
  buffer_load_dwordx4 v[20:23], v1, s[48:51], s72 offen offset:1024 sc1
  s_sub_u32 s60, s60, 1
  s_cbranch_scc1 EXIT
  s_cmp_eq_u32 s64, 63
  v_mov_b64 v[116:117], 0
  v_mov_b64 v[118:119], 0
  v_mov_b64 v[112:113], 0
  v_mov_b64 v[114:115], 0
  s_waitcnt vmcnt(3)
  v_max3_u32 v25, v16, v17, v18
  v_max_u32 v25, v25, v19
  v_smfmac_f32_16x16x64_bf16 v[112:115], v[16:19], v[48:55], v0
  ds_write_b128 v8, v[16:19] offset:32768
  s_waitcnt vmcnt(2)
  v_max3_u32 v25, v25, v20, v21
  v_max3_u32 v25, v25, v22, v23
  v_cmp_eq_u32 vcc, -1, v25
  v_smfmac_f32_16x16x64_bf16 v[116:119], v[16:19], v[88:95], v0
  ds_write_b128 v8, v[20:23] offset:33792
  v_smfmac_f32_16x16x64_bf16 v[112:115], v[20:23], v[96:103], v0
  s_cbranch_vccnz MPS
  v_smfmac_f32_16x16x64_bf16 v[116:119], v[20:23], v[72:79], v0
  v_smfmac_f32_16x16x64_bf16 v[104:107], v[16:19], a[128:135], v0
  v_smfmac_f32_16x16x64_bf16 v[124:127], v[20:23], a[24:31], v0
  v_smfmac_f32_16x16x64_bf16 v[108:111], v[16:19], a[136:143], v0
  s_waitcnt lgkmcnt(0)
  s_barrier
  ds_read_b128 v[24:27], v9 offset:32768
  ds_read_b128 v[32:35], v10 offset:32768
  v_smfmac_f32_16x16x64_bf16 v[104:107], v[20:23], a[144:151], v0
  ds_read_b128 v[36:39], v10 offset:33792
  buffer_store_dwordx4 v[12:15], v1, s[48:51], s75 offen sc1
  v_smfmac_f32_16x16x64_bf16 v[108:111], v[20:23], a[152:159], v0
  ds_read_b128 v[40:43], v11 offset:32768
  v_smfmac_f32_16x16x64_bf16 v[120:123], v[16:19], a[0:7], v0
  ds_read_b128 v[44:47], v11 offset:33792
  v_smfmac_f32_16x16x64_bf16 v[124:127], v[16:19], a[8:15], v0
  ds_read_b128 v[28:31], v9 offset:33792
  s_cbranch_scc1 C_LAST
  s_waitcnt lgkmcnt(5)
  v_smfmac_f32_16x16x64_bf16 v[112:115], v[24:27], v[80:87], v0
  ds_read_b128 v[96:99], v8 offset:12288
  s_waitcnt lgkmcnt(5)
  v_smfmac_f32_16x16x64_bf16 v[112:115], v[32:35], v[128:135], v0
  ds_read_b128 v[100:103], v8 offset:13312
  s_waitcnt lgkmcnt(5)
  v_smfmac_f32_16x16x64_bf16 v[112:115], v[36:39], v[144:151], v0
  ds_read_b128 v[88:91], v8 offset:10240
  s_waitcnt lgkmcnt(5)
  v_smfmac_f32_16x16x64_bf16 v[112:115], v[40:43], v[160:167], v0
  ds_read_b128 v[92:95], v8 offset:11264
  s_waitcnt lgkmcnt(5)
  v_smfmac_f32_16x16x64_bf16 v[112:115], v[44:47], v[176:183], v0
  ds_read_b128 v[48:51], v8 offset:14336
  s_waitcnt lgkmcnt(3)
  v_smfmac_f32_16x16x64_bf16 v[112:115], v[28:31], v[96:103], v0
  ds_read_b128 v[52:55], v8 offset:15360
  s_nop 1
  v_smfmac_f32_16x16x64_bf16 v[116:119], v[32:35], v[136:143], v0
  ds_read_b128 v[72:75], v8 offset:16384
  s_nop 0
  v_smfmac_f32_16x16x64_bf16 v[116:119], v[36:39], v[152:159], v0
  ds_read_b128 v[76:79], v8 offset:17408
  v_add_f32 v112, v112, v114
  v_smfmac_f32_16x16x64_bf16 v[116:119], v[40:43], v[168:175], v0
  ds_read_b128 v[80:83], v8 offset:18432
  v_add_f32 v113, v113, v115
  s_waitcnt lgkmcnt(5)
  v_smfmac_f32_16x16x64_bf16 v[116:119], v[24:27], v[88:95], v0
  ds_read_b128 v[84:87], v8 offset:19456
  v_mul_f32 v112, s78, v112
  v_smfmac_f32_16x16x64_bf16 v[116:119], v[44:47], v[184:191], v0
  v_mul_f32 v113, s78, v113
  s_waitcnt lgkmcnt(4)
  v_smfmac_f32_16x16x64_bf16 v[116:119], v[28:31], v[48:55], v0
  ds_read_b128 v[88:91], v8 offset:20480
  v_cvt_pk_bf16_f32 v114, v112, v113
  v_smfmac_f32_16x16x64_bf16 v[120:123], v[20:23], a[16:23], v0
  ds_write_b32 v3, v114 offset:2048
  v_mov_b64 v[112:113], 0
  ds_read_b128 v[92:95], v8 offset:21504
  buffer_load_dwordx4 v2, s[48:51], s73 offen offset:0 sc1 lds
  v_smfmac_f32_16x16x64_bf16 v[120:123], v[24:27], a[32:39], v0
  v_add_f32 v116, v116, v118
  v_add_f32 v117, v117, v119
  v_mul_f32 v116, s78, v116
  v_mul_f32 v117, s78, v117
  v_cvt_pk_bf16_f32 v118, v116, v117
  ds_write_b32 v3, v118 offset:2560
  v_smfmac_f32_16x16x64_bf16 v[120:123], v[28:31], a[48:55], v0
  buffer_load_dwordx4 v2, s[48:51], s73 offen offset:1024 sc1 lds
  v_mov_b64 v[114:115], 0
  v_smfmac_f32_16x16x64_bf16 v[120:123], v[32:35], a[64:71], v0
  v_mov_b64 v[116:117], 0
  v_smfmac_f32_16x16x64_bf16 v[120:123], v[36:39], a[80:87], v0
  buffer_load_dwordx4 v1, s[48:51], s73 offen offset:2048 sc1 lds
  v_mov_b64 v[118:119], 0
  v_smfmac_f32_16x16x64_bf16 v[120:123], v[40:43], a[96:103], v0
  s_waitcnt lgkmcnt(0)
  s_barrier
  ds_read_b64_tr_b16 v[48:49], v4 offset:2048
  ds_read_b64_tr_b16 v[50:51], v4 offset:2560
  v_smfmac_f32_16x16x64_bf16 v[120:123], v[44:47], a[112:119], v0
  ds_read_b64_tr_b16 v[52:53], v4 offset:3072
  ds_read_b64_tr_b16 v[54:55], v4 offset:3584
  s_nop 0
  v_smfmac_f32_16x16x64_bf16 v[124:127], v[24:27], a[40:47], v0
  buffer_load_dwordx4 v1, s[48:51], s73 offen offset:3072 sc1 lds
  s_add_u32 s73, s73, 0x80000
  s_nop 0
  v_smfmac_f32_16x16x64_bf16 v[124:127], v[28:31], a[56:63], v0
  v_add_f32 v120, v120, v122
  v_smfmac_f32_16x16x64_bf16 v[124:127], v[32:35], a[72:79], v0
  s_waitcnt vmcnt(5) lgkmcnt(2)
  v_add_f32 v121, v121, v123
  v_mfma_f32_16x16x32_bf16 v[96:99], v[56:59], v[48:51], 0
  s_waitcnt lgkmcnt(0)
  v_cvt_pk_bf16_f32 v122, v120, v121
  v_mov_b64 v[20:21], s[82:83]
  v_mfma_f32_16x16x32_bf16 v[96:99], v[60:63], v[52:55], v[96:99]
  ds_write_b32 v3, v122 offset:0
  v_mov_b64 v[120:121], 0
  v_mov_b64 v[22:23], s[82:83]
  v_smfmac_f32_16x16x64_bf16 v[124:127], v[36:39], a[88:95], v0
  s_nop 1
  v_mov_b32 v18, 0
  v_smfmac_f32_16x16x64_bf16 v[124:127], v[40:43], a[104:111], v0
  v_add_f32_dpp v98, v96, v98 quad_perm:[0,1,0,1] row_mask:0xf bank_mask:0xf
  v_smfmac_f32_16x16x64_bf16 v[124:127], v[44:47], a[120:127], v0
  s_nop 1
  v_add_f32_dpp v99, v97, v99 quad_perm:[0,1,0,1] row_mask:0xf bank_mask:0xf
  v_smfmac_f32_16x16x64_bf16 v[104:107], v[24:27], a[160:167], v0
  s_nop 0
  v_exp_f32_dpp v96, v98 quad_perm:[2,3,2,3] row_mask:0xf bank_mask:0xf
  v_smfmac_f32_16x16x64_bf16 v[104:107], v[28:31], a[176:183], v0
  v_exp_f32_dpp v97, v99 quad_perm:[2,3,2,3] row_mask:0xf bank_mask:0xf
  v_add_f32 v124, v124, v126
  v_add_f32 v125, v125, v127
  v_cvt_pk_bf16_f32 v126, v124, v125
  ds_write_b32 v3, v126 offset:512
  v_cvt_pk_bf16_f32 v96, v96, v97
  v_smfmac_f32_16x16x64_bf16 v[104:107], v[32:35], a[192:199], v0
  ds_write_b32 v5, v96 offset:0
  v_mov_b64 v[124:125], 0
  v_smfmac_f32_16x16x64_bf16 v[104:107], v[36:39], a[208:215], v0
  v_smfmac_f32_16x16x64_bf16 v[104:107], v[40:43], a[224:231], v0
  v_smfmac_f32_16x16x64_bf16 v[104:107], v[44:47], a[240:247], v0
  v_smfmac_f32_16x16x64_bf16 v[108:111], v[24:27], a[168:175], v0
  s_waitcnt lgkmcnt(0)
  s_barrier
  ds_read_b64_tr_b16 v[56:57], v4 offset:0
  ds_read_b64_tr_b16 v[58:59], v4 offset:512
  v_smfmac_f32_16x16x64_bf16 v[108:111], v[28:31], a[184:191], v0
  ds_read_b64_tr_b16 v[60:61], v4 offset:1024
  ds_read_b64_tr_b16 v[62:63], v4 offset:1536
  v_add_f32 v104, v104, v106
  v_smfmac_f32_16x16x64_bf16 v[108:111], v[32:35], a[200:207], v0
  ds_read_b128 v[100:103], v1 offset:0
  v_add_f32 v105, v105, v107
  v_smfmac_f32_16x16x64_bf16 v[108:111], v[36:39], a[216:223], v0
  v_smfmac_f32_16x16x64_bf16 v[108:111], v[40:43], a[232:239], v0
  s_add_u32 s75, s75, 0x20000
  v_cvt_pk_bf16_f32 v13, v104, v105
  v_smfmac_f32_16x16x64_bf16 v[108:111], v[44:47], a[248:255], v0
  s_waitcnt lgkmcnt(3)
  v_min_u32 v12, -2, v122
  v_mfma_f32_16x16x32_bf16 v[24:27], v[56:59], v[48:51], 0
  s_waitcnt lgkmcnt(1)
  v_mov_b32 v14, v126
  v_mov_b64 v[122:123], 0
  v_mfma_f32_16x16x32_bf16 v[24:27], v[60:63], v[52:55], v[24:27]
  s_waitcnt lgkmcnt(0)
  v_mov_b64 v[126:127], 0
  v_add_f32 v108, v108, v110
  v_mfma_f32_16x16x32_bf16 v[28:31], v[20:23], v[100:103], 0
  ds_read_b128 v[48:51], v8 offset:22528
  v_add_f32 v109, v109, v111
  v_cvt_pk_bf16_f32 v15, v108, v109
  ds_read_b128 v[52:55], v8 offset:23552
  v_add_f32_dpp v26, v24, v26 quad_perm:[0,1,0,1] row_mask:0xf bank_mask:0xf
  v_add_f32_dpp v27, v25, v27 quad_perm:[0,1,0,1] row_mask:0xf bank_mask:0xf
  v_mfma_f32_16x16x32_bf16 v[32:35], v[64:67], v[100:103], 0
  v_exp_f32_dpp v24, v26 quad_perm:[2,3,2,3] row_mask:0xf bank_mask:0xf
  v_exp_f32_dpp v25, v27 quad_perm:[2,3,2,3] row_mask:0xf bank_mask:0xf
  v_mfma_f32_16x16x32_bf16 v[36:39], v[68:71], v[100:103], 0
  v_cvt_pk_bf16_f32 v19, v24, v25
  ds_read_b128 v[56:59], v8 offset:24576
  ds_read_b128 v[60:63], v8 offset:25600
  v_mfma_f32_16x16x16_bf16 v[28:31], v[20:21], v[18:19], v[28:31]
  ds_read_b128 v[104:107], v8 offset:26624
  s_nop 1
  v_mfma_f32_16x16x16_bf16 v[32:35], v[12:13], v[18:19], v[32:35]
  ds_read_b128 v[108:111], v8 offset:27648
  s_nop 1
  v_mfma_f32_16x16x16_bf16 v[36:39], v[14:15], v[18:19], v[36:39]
  v_rcp_f32 v30, v28
  s_nop 0
  v_max_f32 v28, v28, v30
  v_cmp_lt_f32 vcc, s79, v28
  v_pk_mul_f32 v[32:33], v[32:33], v[30:31] op_sel_hi:[1,0]
  v_pk_mul_f32 v[34:35], v[34:35], v[30:31] op_sel_hi:[1,0]
  v_cvt_pk_bf16_f32 v40, v32, v33
  v_cvt_pk_bf16_f32 v41, v34, v35
  v_pk_mul_f32 v[36:37], v[36:37], v[30:31] op_sel_hi:[1,0]
  v_pk_mul_f32 v[38:39], v[38:39], v[30:31] op_sel_hi:[1,0]
  v_cvt_pk_bf16_f32 v42, v36, v37
  v_cvt_pk_bf16_f32 v43, v38, v39
  ds_write_b128 v8, v[40:43] offset:32768
  s_cbranch_vccnz FBKS
FRETS:
  v_smfmac_f32_16x16x64_bf16 v[112:115], v[40:43], v[192:199], v0
  s_add_u32 s64, s64, 1
  s_and_b32 s56, s64, 3
  s_lshl_b32 s56, s56, 13
  v_smfmac_f32_16x16x64_bf16 v[116:119], v[40:43], v[200:207], v0
  s_add_u32 s74, s56, 88080384
  s_add_u32 s72, s74, s87
  s_xor_b32 s88, s74, 0x4000
  v_smfmac_f32_16x16x64_bf16 v[120:123], v[40:43], v[208:215], v0
  s_cmp_lt_u32 s52, 2
  s_waitcnt lgkmcnt(0)
  s_barrier
  ds_read_b128 v[64:67], v9 offset:32768
  ds_read_b128 v[68:71], v10 offset:32768
  ds_read_b128 v[24:27], v11 offset:32768
  v_smfmac_f32_16x16x64_bf16 v[124:127], v[40:43], v[216:223], v0
  ds_read_b128 v[96:99], v8 offset:28672
  ds_read_b128 v[100:103], v8 offset:29696
  s_waitcnt lgkmcnt(4)
  v_smfmac_f32_16x16x64_bf16 v[112:115], v[64:67], v[224:231], v0
  s_waitcnt lgkmcnt(3)
  v_smfmac_f32_16x16x64_bf16 v[112:115], v[68:71], v[72:79], v0
  s_waitcnt lgkmcnt(2)
  v_mov_b32 v42, -1
  v_smfmac_f32_16x16x64_bf16 v[112:115], v[24:27], v[80:87], v0
  ds_read_b128 v[16:19], v8 offset:30720
  s_nop 1
  v_smfmac_f32_16x16x64_bf16 v[116:119], v[64:67], v[232:239], v0
  ds_read_b128 v[20:23], v8 offset:31744
  s_nop 0
  v_smfmac_f32_16x16x64_bf16 v[116:119], v[68:71], v[88:95], v0
  ds_read_b128 v[44:47], v1 offset:3072
  v_cvt_pk_bf16_f32 v32, v112, v113
  v_smfmac_f32_16x16x64_bf16 v[116:119], v[24:27], v[48:55], v0
  s_nop 1
  v_and_or_b32 v32, v32, -2, s76
  v_smfmac_f32_16x16x64_bf16 v[120:123], v[64:67], v[240:247], v0
  s_nop 1
  v_cvt_pk_bf16_f32 v33, v114, v115
  v_smfmac_f32_16x16x64_bf16 v[120:123], v[68:71], v[56:63], v0
  v_cvt_pk_bf16_f32 v34, v116, v117
  v_cvt_pk_bf16_f32 v35, v118, v119
  buffer_store_dwordx4 v[32:35], v6, s[48:51], s71 offen sc1
  v_smfmac_f32_16x16x64_bf16 v[120:123], v[24:27], v[104:111], v0
  s_waitcnt lgkmcnt(0)
  s_nop 1
  v_smfmac_f32_16x16x64_bf16 v[124:127], v[64:67], v[248:255], v0
  s_nop 2
  v_smfmac_f32_16x16x64_bf16 v[124:127], v[68:71], v[96:103], v0
  v_cvt_pk_bf16_f32 v36, v120, v121
  v_smfmac_f32_16x16x64_bf16 v[124:127], v[24:27], v[16:23], v0
  s_nop 1
  v_and_or_b32 v36, v36, -2, s76
  v_cvt_pk_bf16_f32 v37, v122, v123
  s_nop 3
  v_cvt_pk_bf16_f32 v38, v124, v125
  v_cvt_pk_bf16_f32 v39, v126, v127
  buffer_store_dwordx4 v[36:39], v6, s[48:51], s86 offen sc1
  ds_read_b128 v[48:51], v8 offset:0
  ds_read_b128 v[52:55], v8 offset:1024
  ds_read_b128 v[88:91], v8 offset:2048
  ds_read_b128 v[92:95], v8 offset:3072
  ds_read_b128 v[96:99], v8 offset:4096
  ds_read_b128 v[100:103], v8 offset:5120
  ds_read_b128 v[72:75], v8 offset:6144
  ds_read_b128 v[76:79], v8 offset:7168
  ds_read_b128 v[80:83], v8 offset:8192
  ds_read_b128 v[84:87], v8 offset:9216
  s_cbranch_scc1 REDS
  s_waitcnt vmcnt(2)
  ds_read_b128 v[56:59], v8 offset:34816
  ds_read_b128 v[60:63], v8 offset:35840
  ds_read_b128 v[64:67], v8 offset:36864
  ds_read_b128 v[68:71], v8 offset:37888
  buffer_store_dword v42, v7, s[48:51], s88 offen sc1
  s_cmp_eq_u32 s52, 3
  s_cbranch_scc0 JOINS
  s_add_u32 s59, s64, 1
  s_min_u32 s59, s59, 63
  s_cmp_gt_u32 s70, s59
  s_cbranch_scc1 RDY_OKS
RDY_PS:
  buffer_load_dwordx4 v[24:27], off, s[48:51], s77 sc1
  buffer_load_dwordx4 v[28:31], off, s[48:51], s77 offset:16 sc1
  s_sub_u32 s60, s60, 1
  s_cbranch_scc1 EXIT
  s_waitcnt vmcnt(0)
  v_mad_u32_u24 v25, v25, 7, 0
  v_mad_u32_u24 v26, v26, 7, 1
  v_mad_u32_u24 v27, v27, 7, 2
  v_mad_u32_u24 v28, v28, 7, 3
  v_mad_u32_u24 v29, v29, 7, 4
  v_mad_u32_u24 v30, v30, 7, 5
  v_mad_u32_u24 v31, v31, 7, 6
  v_min3_u32 v24, v25, v26, v27
  v_min3_u32 v24, v24, v28, v29
  v_min3_u32 v24, v24, v30, v31
  s_nop 0
  v_readfirstlane_b32 s70, v24
  s_cmp_gt_u32 s70, s59
  s_cbranch_scc0 RDY_PS
RDY_OKS:
JOINS:
  s_xor_b32 s76, s76, 1
  s_waitcnt lgkmcnt(0)
  s_barrier
  s_branch LOOPS
FBKS:
  v_mov_b32_dpp v98, v98 quad_perm:[2,3,2,3] row_mask:0xf bank_mask:0xf
  v_mov_b32_dpp v99, v99 quad_perm:[2,3,2,3] row_mask:0xf bank_mask:0xf
  v_mov_b32_dpp v26, v26 quad_perm:[2,3,2,3] row_mask:0xf bank_mask:0xf
  v_mov_b32_dpp v27, v27 quad_perm:[2,3,2,3] row_mask:0xf bank_mask:0xf
  ds_write_b32 v5, v98 offset:1024
  ds_write_b32 v5, v99 offset:2048
  s_waitcnt lgkmcnt(0)
  s_barrier
  ds_read_b128 v[32:35], v1 offset:1024
  ds_read_b128 v[36:39], v1 offset:2048
  v_max_f32 v28, v26, v27
  s_waitcnt lgkmcnt(0)
  v_max3_f32 v28, v28, v32, v33
  v_max3_f32 v28, v28, v34, v35
  v_max3_f32 v28, v28, v36, v37
  v_max3_f32 v28, v28, v38, v39
  v_mov_b32 v29, v28
  s_nop 1
  v_permlane16_swap_b32 v28, v29
  v_max_f32 v28, v28, v29
  v_mov_b32 v29, v28
  s_nop 1
  v_permlane32_swap_b32 v28, v29
  v_max_f32 v28, v28, v29
  v_sub_f32 v32, v32, v28
  v_sub_f32 v33, v33, v28
  v_sub_f32 v34, v34, v28
  v_sub_f32 v35, v35, v28
  v_sub_f32 v36, v36, v28
  v_sub_f32 v37, v37, v28
  v_sub_f32 v38, v38, v28
  v_sub_f32 v39, v39, v28
  v_sub_f32 v26, v26, v28
  v_sub_f32 v27, v27, v28
  v_exp_f32 v32, v32
  v_exp_f32 v33, v33
  v_exp_f32 v34, v34
  v_exp_f32 v35, v35
  v_exp_f32 v36, v36
  v_exp_f32 v37, v37
  v_exp_f32 v38, v38
  v_exp_f32 v39, v39
  v_cvt_pk_bf16_f32 v100, v32, v36
  v_cvt_pk_bf16_f32 v101, v33, v37
  v_cvt_pk_bf16_f32 v102, v34, v38
  v_cvt_pk_bf16_f32 v103, v35, v39
  s_nop 1
  v_mfma_f32_16x16x32_bf16 v[28:31], v[20:23], v[100:103], 0
  v_mfma_f32_16x16x32_bf16 v[32:35], v[64:67], v[100:103], 0
  v_exp_f32_dpp v24, v26 quad_perm:[2,3,2,3] row_mask:0xf bank_mask:0xf
  v_exp_f32_dpp v25, v27 quad_perm:[2,3,2,3] row_mask:0xf bank_mask:0xf
  v_mfma_f32_16x16x32_bf16 v[36:39], v[68:71], v[100:103], 0
  s_nop 0
  v_cvt_pk_bf16_f32 v19, v24, v25
  s_nop 1
  v_mfma_f32_16x16x16_bf16 v[28:31], v[20:21], v[18:19], v[28:31]
  s_nop 2
  v_mfma_f32_16x16x16_bf16 v[32:35], v[12:13], v[18:19], v[32:35]
  s_nop 2
  v_mfma_f32_16x16x16_bf16 v[36:39], v[14:15], v[18:19], v[36:39]
  v_rcp_f32 v30, v28
  s_nop 2
  v_pk_mul_f32 v[32:33], v[32:33], v[30:31] op_sel_hi:[1,0]
  v_pk_mul_f32 v[34:35], v[34:35], v[30:31] op_sel_hi:[1,0]
  v_cvt_pk_bf16_f32 v40, v32, v33
  v_cvt_pk_bf16_f32 v41, v34, v35
  v_pk_mul_f32 v[36:37], v[36:37], v[30:31] op_sel_hi:[1,0]
  v_pk_mul_f32 v[38:39], v[38:39], v[30:31] op_sel_hi:[1,0]
  v_cvt_pk_bf16_f32 v42, v36, v37
  v_cvt_pk_bf16_f32 v43, v38, v39
  ds_write_b128 v8, v[40:43] offset:32768
  s_branch FRETS
REDS:
  s_cmp_eq_u32 s52, 0
  s_cbranch_scc1 PWS
  s_nop 13
PWS:
  s_nop 15
  s_nop 9
  s_waitcnt vmcnt(2)
PPS:
  buffer_load_dwordx4 v[24:27], v1, s[48:51], s85 offen offset:0 sc1
  buffer_load_dwordx4 v[28:31], v1, s[48:51], s85 offen offset:1024 sc1
  buffer_load_dwordx4 v[32:35], v1, s[48:51], s85 offen offset:2048 sc1
  buffer_load_dwordx4 v[36:39], v1, s[48:51], s85 offen offset:3072 sc1
  ds_read_b128 v[56:59], v8 offset:34816
  ds_read_b128 v[60:63], v8 offset:35840
  ds_read_b128 v[64:67], v8 offset:36864
  ds_read_b128 v[68:71], v8 offset:37888
  s_nop 15
  s_nop 15
PQS:
  buffer_load_dwordx4 v[112:115], v1, s[48:51], s85 offen offset:0 sc1
  buffer_load_dwordx4 v[116:119], v1, s[48:51], s85 offen offset:1024 sc1
  buffer_load_dwordx4 v[120:123], v1, s[48:51], s85 offen offset:2048 sc1
  buffer_load_dwordx4 v[124:127], v1, s[48:51], s85 offen offset:3072 sc1
  s_waitcnt vmcnt(7)
  v_mfma_f32_16x16x32_bf16 v[20:23], v[44:47], v[24:27], 0
  s_waitcnt vmcnt(6)
  v_mfma_f32_16x16x32_bf16 v[20:23], v[44:47], v[28:31], v[20:23]
  v_bitop3_b32 v40, v24, v28, s76 bitop3:0x7e
  s_waitcnt vmcnt(5)
  v_mfma_f32_16x16x32_bf16 v[20:23], v[44:47], v[32:35], v[20:23]
  s_waitcnt vmcnt(4)
  v_mfma_f32_16x16x32_bf16 v[20:23], v[44:47], v[36:39], v[20:23]
  s_nop 0
  v_bitop3_b32 v41, v32, v36, s76 bitop3:0x7e
  v_bitop3_b32 v40, v40, 1, v41 bitop3:0xc8
  v_cmp_ne_u32 vcc, 0, v40
  s_nop 3
  v_add_f32_dpp v20, v20, v20 row_ror:8 row_mask:0xf bank_mask:0xf
  v_add_f32_dpp v21, v21, v21 row_ror:8 row_mask:0xf bank_mask:0xf
  v_cvt_pk_bf16_f32 v41, v20, v21
  v_min_u32 v41, -2, v41
  s_cbranch_vccnz PFS
PDS:
  buffer_store_dword v41, v7, s[48:51], s74 offen sc1
  s_barrier
  s_xor_b32 s76, s76, 1
  s_branch LOOPS
PFS:
  buffer_load_dwordx4 v[24:27], v1, s[48:51], s85 offen offset:0 sc1
  buffer_load_dwordx4 v[28:31], v1, s[48:51], s85 offen offset:1024 sc1
  buffer_load_dwordx4 v[32:35], v1, s[48:51], s85 offen offset:2048 sc1
  buffer_load_dwordx4 v[36:39], v1, s[48:51], s85 offen offset:3072 sc1
  s_waitcnt vmcnt(7)
  v_mfma_f32_16x16x32_bf16 v[20:23], v[44:47], v[112:115], 0
  s_waitcnt vmcnt(6)
  v_mfma_f32_16x16x32_bf16 v[20:23], v[44:47], v[116:119], v[20:23]
  v_bitop3_b32 v40, v112, v116, s76 bitop3:0x7e
  s_waitcnt vmcnt(5)
  v_mfma_f32_16x16x32_bf16 v[20:23], v[44:47], v[120:123], v[20:23]
  s_waitcnt vmcnt(4)
  v_mfma_f32_16x16x32_bf16 v[20:23], v[44:47], v[124:127], v[20:23]
  s_nop 0
  v_bitop3_b32 v41, v120, v124, s76 bitop3:0x7e
  v_bitop3_b32 v40, v40, 1, v41 bitop3:0xc8
  v_cmp_ne_u32 vcc, 0, v40
  s_nop 3
  v_add_f32_dpp v20, v20, v20 row_ror:8 row_mask:0xf bank_mask:0xf
  v_add_f32_dpp v21, v21, v21 row_ror:8 row_mask:0xf bank_mask:0xf
  v_cvt_pk_bf16_f32 v41, v20, v21
  v_min_u32 v41, -2, v41
  s_cbranch_vccnz PGS
  buffer_store_dword v41, v7, s[48:51], s74 offen sc1
  s_barrier
  s_xor_b32 s76, s76, 1
  s_branch LOOPS
PGS:
  s_sub_u32 s60, s60, 1
  s_cbranch_scc1 EXIT
  s_branch PQS
C_LAST:
  buffer_store_dwordx4 v[12:15], v1, s[48:51], s75 offen sc1
  s_add_u32 s75, s75, 0x20000
  s_waitcnt lgkmcnt(0)
  v_smfmac_f32_16x16x64_bf16 v[104:107], v[24:27], a[160:167], v0
  v_smfmac_f32_16x16x64_bf16 v[108:111], v[24:27], a[168:175], v0
  v_smfmac_f32_16x16x64_bf16 v[104:107], v[28:31], a[176:183], v0
  v_smfmac_f32_16x16x64_bf16 v[108:111], v[28:31], a[184:191], v0
  v_smfmac_f32_16x16x64_bf16 v[104:107], v[32:35], a[192:199], v0
  v_smfmac_f32_16x16x64_bf16 v[108:111], v[32:35], a[200:207], v0
  v_smfmac_f32_16x16x64_bf16 v[104:107], v[36:39], a[208:215], v0
  v_smfmac_f32_16x16x64_bf16 v[108:111], v[36:39], a[216:223], v0
  v_smfmac_f32_16x16x64_bf16 v[104:107], v[40:43], a[224:231], v0
  v_smfmac_f32_16x16x64_bf16 v[108:111], v[40:43], a[232:239], v0
  v_smfmac_f32_16x16x64_bf16 v[104:107], v[44:47], a[240:247], v0
  v_smfmac_f32_16x16x64_bf16 v[108:111], v[44:47], a[248:255], v0
  v_smfmac_f32_16x16x64_bf16 v[120:123], v[20:23], a[16:23], v0
  v_smfmac_f32_16x16x64_bf16 v[120:123], v[24:27], a[32:39], v0
  v_smfmac_f32_16x16x64_bf16 v[124:127], v[24:27], a[40:47], v0
  v_smfmac_f32_16x16x64_bf16 v[120:123], v[28:31], a[48:55], v0
  v_smfmac_f32_16x16x64_bf16 v[124:127], v[28:31], a[56:63], v0
  v_smfmac_f32_16x16x64_bf16 v[120:123], v[32:35], a[64:71], v0
  v_smfmac_f32_16x16x64_bf16 v[124:127], v[32:35], a[72:79], v0
  v_smfmac_f32_16x16x64_bf16 v[120:123], v[36:39], a[80:87], v0
  v_smfmac_f32_16x16x64_bf16 v[124:127], v[36:39], a[88:95], v0
  v_smfmac_f32_16x16x64_bf16 v[120:123], v[40:43], a[96:103], v0
  v_smfmac_f32_16x16x64_bf16 v[124:127], v[40:43], a[104:111], v0
  v_smfmac_f32_16x16x64_bf16 v[120:123], v[44:47], a[112:119], v0
  s_nop 2
  v_smfmac_f32_16x16x64_bf16 v[124:127], v[44:47], a[120:127], v0
  s_nop 1
  v_pk_add_f32 v[104:105], v[104:105], v[106:107]
  v_pk_add_f32 v[108:109], v[108:109], v[110:111]
  v_cvt_pk_bf16_f32 v73, v104, v105
  v_cvt_pk_bf16_f32 v75, v108, v109
  v_pk_add_f32 v[120:121], v[120:121], v[122:123]
  s_nop 0
  v_pk_add_f32 v[124:125], v[124:125], v[126:127]
  v_cvt_pk_bf16_f32 v72, v120, v121
  v_cvt_pk_bf16_f32 v74, v124, v125
  v_min_u32 v72, -2, v72
  buffer_store_dwordx4 v[72:75], v1, s[48:51], s75 offen sc1
  s_waitcnt vmcnt(0)
EXIT:
  s_endpgm
.section .rodata,"a"
.p2align 6
.amdhsa_kernel recurrent_scan__memory_aug_recurrent_mem_tr__glu_gated_geglu__prompt_kernel
  .amdhsa_next_free_vgpr 512
  .amdhsa_next_free_sgpr 102
  .amdhsa_accum_offset 256
  .amdhsa_group_segment_fixed_size 0
  .amdhsa_kernarg_size 112
  .amdhsa_user_sgpr_count 2
  .amdhsa_user_sgpr_kernarg_segment_ptr 1
  .amdhsa_system_sgpr_workgroup_id_x 1
.end_amdhsa_kernel
```
